```python
import torch

def _softmax(x, axis=-1):
    return torch.softmax(x, dim=axis)
def _gelu(x):
    return torch.nn.functional.gelu(x, approximate="tanh")
def _silu(x):
    return torch.nn.functional.silu(x)
def _sigmoid(x):
    return torch.sigmoid(x)
def _layernorm(x, axis=-1, eps=1e-5):
    m = x.mean(dim=axis, keepdim=True)
    v = x.var(dim=axis, keepdim=True, unbiased=False)
    return (x - m) / torch.sqrt(v + eps)
def _scatter_add(tgt, idx, src, axis=0):
    return tgt.clone().index_add_(axis, idx, src)
def _segment_sum(src, seg, n):
    out = torch.zeros((n,) + src.shape[1:], dtype=src.dtype)
    return out.index_add_(0, seg, src)
def _pad(x, pw):
    flat = tuple(v for pair in reversed(pw) for v in pair)
    return torch.nn.functional.pad(x, flat)

kernel_name = 'gated_mix__grouped_kv_mqa__moe_arch_mod__prompt'

def setup_inputs():

    _w = (lambda a: (lambda t: t.to(torch.bfloat16) if t.is_floating_point() else t)(torch.as_tensor(a)))
    def _A_setup():
        B, S, D, H = 1, 2048, 1024, 32
        Dh = D // H
        return {
            "x": _w((lambda *s: torch.randn(*s, dtype=torch.bfloat16) * 0.05)(B, S, D)),
            "wq": _w((lambda *s: torch.randn(*s, dtype=torch.bfloat16) * 0.8)(D, H * Dh)),
            "wk": _w((lambda *s: torch.randn(*s, dtype=torch.bfloat16) * 0.8)(D, Dh)),
            "wv": _w((lambda *s: torch.randn(*s, dtype=torch.bfloat16) * 0.1)(D, Dh)),
            "wo": _w((lambda *s: torch.randn(*s, dtype=torch.bfloat16) * 0.1)(H * Dh, D)),
        }
    _A_in = _A_setup()

    def _B_setup():
        B, S, D, F, C = 1, 2048, 1024, 3584, 8
        return {
            "x": _w((lambda *s: torch.randn(*s, dtype=torch.bfloat16) * 0.05)(B, S, D)),
            "w_r": _w((lambda *s: torch.randn(*s, dtype=torch.bfloat16) * 1.6)(D)),
            "w_gate": _w((lambda *s: torch.randn(*s, dtype=torch.bfloat16) * 0.1)(D, F)),
            "w_up": _w((lambda *s: torch.randn(*s, dtype=torch.bfloat16) * 0.1)(D, F)),
            "w_down": _w((lambda *s: torch.randn(*s, dtype=torch.bfloat16) * 0.1)(F, D)),
        }
    _B_in = _B_setup()

    return {
        "A_x": _A_in["x"],
        "A_wq": _A_in["wq"],
        "A_wk": _A_in["wk"],
        "A_wv": _A_in["wv"],
        "A_wo": _A_in["wo"],
        "B_x": _B_in["x"],
        "B_w_r": _B_in["w_r"],
        "B_w_gate": _B_in["w_gate"],
        "B_w_up": _B_in["w_up"],
        "B_w_down": _B_in["w_down"],
        "gate_w": _w((lambda *s: torch.randn(*s, dtype=torch.bfloat16) * 0.05)(1024) * 16.0),
    }

def reference(A_x, A_wq, A_wk, A_wv, A_wo, B_x, B_w_r, B_w_gate, B_w_up, B_w_down, gate_w):
    def _A_ref(x, wq, wk, wv, wo):
        B, S, D = x.shape
        H = 32
        Dh = D // H
        q = (lambda x, *d: x.permute(*d))((x @ wq).reshape(B, S, H, Dh), 0, 2, 1, 3)
        k = x @ wk
        v = x @ wv
        scores = torch.einsum("bhqd,bkd->bhqk", q, k) * (Dh ** -0.5)
        p = _softmax(scores, axis=-1)
        o = torch.einsum("bhqk,bkd->bhqd", p, v)
        return (lambda x, *d: x.permute(*d))(o, 0, 2, 1, 3).reshape(B, S, H * Dh) @ wo

    def _B_ref(x, w_r, w_gate, w_up, w_down):
        B, S, D = x.shape
        C = 8
        r = x @ w_r
        idx = torch.argsort(-r, axis=-1)[:, :C]
        idx_e = (lambda x, n, axis: torch.repeat_interleave(x, n, dim=axis))(idx.reshape(B, C, 1), D, axis=2)
        x_sel = (lambda x, i, axis: torch.take_along_dim(x, i, dim=axis))(x, idx_e, axis=1)
        g = _silu(x_sel @ w_gate)
        u = x_sel @ w_up
        y = (g * u) @ w_down
        r_sel = _sigmoid((lambda x, i, axis: torch.take_along_dim(x, i, dim=axis))(r, idx, axis=1))
        y = y * r_sel.reshape(B, C, 1)
        b_off = (torch.arange(B) * S).reshape(B, 1)
        flat_idx = (idx + b_off).reshape(B * C)
        zero = (x * 0.0).reshape(B * S, D)
        upd = _scatter_add(zero, flat_idx, y.reshape(B * C, D), axis=0)
        return x + upd.reshape(B, S, D)

    x = A_x
    g = _sigmoid((x * gate_w).sum(-1, keepdims=True))
    a = _A_ref(x, A_wq, A_wk, A_wv, A_wo)
    b = _B_ref(x, B_w_r, B_w_gate, B_w_up, B_w_down)
    return g * a + (1 - g) * b
```

```asm
; @launch grid=(256,1,1) block=(512,1,1) lds=156864
.amdgcn_target "amdgcn-amd-amdhsa--gfx950"
.text
.globl gated_mix__grouped_kv_mqa__moe_arch_mod__prompt_kernel
.p2align 8
.type gated_mix__grouped_kv_mqa__moe_arch_mod__prompt_kernel,@function
gated_mix__grouped_kv_mqa__moe_arch_mod__prompt_kernel:
    s_cmp_ge_u32 s2, 256
    s_cbranch_scc1 K_end
    s_load_dwordx8 s[4:11], s[0:1], 0
    s_load_dwordx16 s[16:31], s[0:1], 48
    s_load_dwordx2 s[12:13], s[0:1], 32
    v_lshrrev_b32 v2, 6, v0
    v_and_b32 v1, 63, v0
    s_and_b32 s53, s2, 7
    v_readfirstlane_b32 s42, v2
    v_lshlrev_b32 v3, 4, v1
    s_lshr_b32 s54, s2, 3
    s_lshr_b32 s40, s53, 1
    s_lshl_b32 s40, s40, 3
    s_and_b32 s55, s54, 7
    s_add_u32 s40, s40, s55
    s_and_b32 s43, s53, 1
    s_lshl_b32 s41, s43, 2
    s_lshr_b32 s44, s54, 3
    s_add_u32 s41, s41, s44
    s_lshl_b32 s59, s55, 1
    s_mul_i32 s62, s53, 28
    s_add_u32 s62, s62, s54
    s_cmp_lt_u32 s54, 28
    s_cselect_b32 s61, 1, 0
    s_cmp_ge_u32 s42, 2
    s_cbranch_scc1 K_notld
    v_lshrrev_b32 v13, 4, v1
    v_lshlrev_b32 v14, 2, v13
    v_and_b32 v15, 15, v1
    v_xor_b32 v14, v14, v15
    v_lshlrev_b32 v8, 11, v13
    v_lshl_add_u32 v8, v14, 4, v8
    s_lshl_b32 s53, s41, 8
    v_add_u32 v8, s53, v8
    v_add_u32 v9, 0x1c00, v8
    v_add_u32 v10, 0x3800, v8
    v_add_u32 v11, 0x5400, v8
    s_waitcnt lgkmcnt(0)
    s_cmp_eq_u32 s43, 0
    s_cselect_b32 s64, s8, s10
    s_cselect_b32 s65, s9, s11
    s_mov_b32 s66, 0x10000
    s_mov_b32 s67, 0x00020000
    s_mov_b32 s68, s6
    s_mov_b32 s69, s7
    s_mov_b32 s70, 0x200000
    s_mov_b32 s71, 0x00020000
    s_mov_b32 s32, s30
    s_mov_b32 s33, s31
    s_mov_b32 s34, 0xc00000
    s_mov_b32 s35, 0x00020000
    s_cmp_eq_u32 s42, 0
    s_cbranch_scc1 K_ldx
    s_mov_b32 s45, 0
    s_mov_b32 s49, 0
P1w_ld:
    s_cmp_ge_u32 s49, 4
    s_cbranch_scc1 P1w_q
    s_add_u32 m0, s45, 8192
    s_lshl_b32 s47, s49, 14
    buffer_load_dwordx4 v3, s[64:67], s47 offen offset:0 lds
    buffer_load_dwordx4 v3, s[64:67], s47 offen offset:1024 lds
    buffer_load_dwordx4 v3, s[64:67], s47 offen offset:2048 lds
    buffer_load_dwordx4 v3, s[64:67], s47 offen offset:3072 lds
    s_add_u32 m0, s45, 12288
    s_lshl_b32 s47, s49, 14
    s_add_u32 s47, s47, 4096
    buffer_load_dwordx4 v3, s[64:67], s47 offen offset:0 lds
    buffer_load_dwordx4 v3, s[64:67], s47 offen offset:1024 lds
    buffer_load_dwordx4 v3, s[64:67], s47 offen offset:2048 lds
    buffer_load_dwordx4 v3, s[64:67], s47 offen offset:3072 lds
    s_add_u32 m0, s45, 16384
    s_lshl_b32 s47, s49, 14
    s_add_u32 s47, s47, 8192
    buffer_load_dwordx4 v3, s[64:67], s47 offen offset:0 lds
    buffer_load_dwordx4 v3, s[64:67], s47 offen offset:1024 lds
    buffer_load_dwordx4 v3, s[64:67], s47 offen offset:2048 lds
    buffer_load_dwordx4 v3, s[64:67], s47 offen offset:3072 lds
    s_branch P1w_nx
P1w_q:
    s_add_u32 m0, s45, 8192
    s_lshl_b32 s47, s59, 17
    buffer_load_dwordx4 v8, s[68:71], s47 offen offset:0 lds
    buffer_load_dwordx4 v9, s[68:71], s47 offen offset:1024 lds
    buffer_load_dwordx4 v10, s[68:71], s47 offen offset:2048 lds
    buffer_load_dwordx4 v11, s[68:71], s47 offen offset:3072 lds
    s_add_u32 m0, s45, 12288
    s_add_u32 s47, s47, 0x8000
    buffer_load_dwordx4 v8, s[68:71], s47 offen offset:0 lds
    buffer_load_dwordx4 v9, s[68:71], s47 offen offset:1024 lds
    buffer_load_dwordx4 v10, s[68:71], s47 offen offset:2048 lds
    buffer_load_dwordx4 v11, s[68:71], s47 offen offset:3072 lds
    s_add_u32 m0, s45, 16384
    s_add_u32 s47, s47, 0x8000
    buffer_load_dwordx4 v8, s[68:71], s47 offen offset:0 lds
    buffer_load_dwordx4 v9, s[68:71], s47 offen offset:1024 lds
    buffer_load_dwordx4 v10, s[68:71], s47 offen offset:2048 lds
    buffer_load_dwordx4 v11, s[68:71], s47 offen offset:3072 lds
    s_add_u32 s59, s59, 1
    s_and_b32 s59, s59, 15
P1w_nx:
    s_add_u32 s45, s45, 24576
    s_cmp_eq_u32 s45, 98304
    s_cselect_b32 s45, 0, s45
    s_add_u32 s49, s49, 1
    s_cmp_lt_u32 s49, 3
    s_cbranch_scc1 P1w_ld
    s_cmp_lt_u32 s49, 20
    s_waitcnt vmcnt(24)
    s_barrier
    s_cbranch_scc1 P1w_ld
    s_waitcnt vmcnt(12)
    s_barrier
    s_waitcnt vmcnt(0)
    s_barrier
    s_barrier
    s_branch K_A1
K_ldx:
    s_mov_b32 s36, s4
    s_mov_b32 s37, s5
    s_mov_b32 s38, 0x400000
    s_mov_b32 s39, 0x00020000
    v_lshrrev_b32 v12, 5, v1
    s_lshl_b32 s53, s40, 6
    s_lshl_b32 s54, s44, 4
    s_add_u32 s54, s54, s53
    v_add_u32 v14, s54, v12
    v_lshlrev_b32 v14, 11, v14
    v_and_b32 v15, 31, v1
    v_xor_b32 v15, v15, v12
    v_lshl_add_u32 v16, v15, 4, v14
    v_xor_b32 v17, 32, v16
    v_xor_b32 v18, 64, v16
    v_xor_b32 v19, 96, v16
    v_xor_b32 v20, 128, v16
    v_xor_b32 v21, 160, v16
    v_xor_b32 v22, 192, v16
    v_xor_b32 v23, 224, v16
    v_add_u32 v17, 3072, v17
    v_add_u32 v18, 6144, v18
    v_add_u32 v19, 9216, v19
    v_add_u32 v20, 16384, v20
    v_add_u32 v21, 19456, v21
    v_add_u32 v22, 22528, v22
    v_add_u32 v23, 25600, v23
    v_lshrrev_b32 v14, 3, v1
    v_add_u32 v14, s53, v14
    v_lshlrev_b32 v14, 11, v14
    v_xor_b32 v15, v13, v1
    v_and_b32 v15, 7, v15
    v_lshl_add_u32 v4, v15, 4, v14
    v_xor_b32 v15, 4, v15
    v_lshl_add_u32 v5, v15, 4, v14
    v_add_u32 v5, 0x3c00, v5
    v_add_u32 v6, 0x7800, v4
    v_add_u32 v7, 0x7800, v5
    s_mov_b32 s45, 0
    s_mov_b32 s49, 0
P1x_ld:
    s_cmp_ge_u32 s49, 4
    s_cbranch_scc1 P1x_q
    s_mov_b32 m0, s45
    s_lshl_b32 s46, s49, 9
    buffer_load_dwordx4 v16, s[36:39], s46 offen offset:0 lds
    buffer_load_dwordx4 v17, s[36:39], s46 offen offset:1024 lds
    buffer_load_dwordx4 v18, s[36:39], s46 offen offset:2048 lds
    buffer_load_dwordx4 v19, s[36:39], s46 offen offset:3072 lds
    s_add_u32 m0, s45, 0x1000
    s_nop 0
    buffer_load_dwordx4 v20, s[36:39], s46 offen offset:0 lds
    buffer_load_dwordx4 v21, s[36:39], s46 offen offset:1024 lds
    buffer_load_dwordx4 v22, s[36:39], s46 offen offset:2048 lds
    buffer_load_dwordx4 v23, s[36:39], s46 offen offset:3072 lds
    s_add_u32 m0, s45, 20480
    s_lshl_b32 s47, s49, 14
    s_add_u32 s47, s47, 12288
    buffer_load_dwordx4 v3, s[64:67], s47 offen offset:0 lds
    buffer_load_dwordx4 v3, s[64:67], s47 offen offset:1024 lds
    buffer_load_dwordx4 v3, s[64:67], s47 offen offset:2048 lds
    buffer_load_dwordx4 v3, s[64:67], s47 offen offset:3072 lds
    s_branch P1x_nx
P1x_q:
    s_mov_b32 m0, s45
    s_lshl_b32 s46, s59, 7
    buffer_load_dwordx4 v4, s[36:39], s46 offen offset:0 lds
    buffer_load_dwordx4 v5, s[36:39], s46 offen offset:1024 lds
    buffer_load_dwordx4 v6, s[36:39], s46 offen offset:2048 lds
    buffer_load_dwordx4 v7, s[36:39], s46 offen offset:3072 lds
    s_add_u32 m0, s45, 0x1000
    s_add_u32 s46, s46, 0x10000
    buffer_load_dwordx4 v4, s[36:39], s46 offen offset:0 lds
    buffer_load_dwordx4 v5, s[36:39], s46 offen offset:1024 lds
    buffer_load_dwordx4 v6, s[36:39], s46 offen offset:2048 lds
    buffer_load_dwordx4 v7, s[36:39], s46 offen offset:3072 lds
    s_lshl_b32 s47, s59, 17
    s_add_u32 m0, s45, 20480
    s_add_u32 s47, s47, 0x18000
    buffer_load_dwordx4 v8, s[68:71], s47 offen offset:0 lds
    buffer_load_dwordx4 v9, s[68:71], s47 offen offset:1024 lds
    buffer_load_dwordx4 v10, s[68:71], s47 offen offset:2048 lds
    buffer_load_dwordx4 v11, s[68:71], s47 offen offset:3072 lds
    s_add_u32 s59, s59, 1
    s_and_b32 s59, s59, 15
P1x_nx:
    s_add_u32 s45, s45, 24576
    s_cmp_eq_u32 s45, 98304
    s_cselect_b32 s45, 0, s45
    s_add_u32 s49, s49, 1
    s_cmp_lt_u32 s49, 3
    s_cbranch_scc1 P1x_ld
    s_cmp_lt_u32 s49, 20
    s_waitcnt vmcnt(24)
    s_barrier
    s_cbranch_scc1 P1x_ld
    s_waitcnt vmcnt(12)
    s_barrier
    s_waitcnt vmcnt(0)
    s_barrier
    s_barrier
    s_branch K_A0
K_notld:
    s_cmp_ge_u32 s42, 4
    s_cbranch_scc1 K_comp
    s_sub_u32 s60, s42, 2
    v_mov_b32 v24, -1
    v_mov_b32 v25, -1
    v_mov_b32 v26, -1
    v_mov_b32 v27, -1
    v_mov_b32 v28, 0
    s_waitcnt lgkmcnt(0)
    s_mov_b32 s32, s30
    s_mov_b32 s33, s31
    s_mov_b32 s34, 0xc00000
    s_mov_b32 s35, 0x00020000
    s_mov_b32 s36, s28
    s_mov_b32 s37, s29
    s_mov_b32 s38, 0x100
    s_mov_b32 s39, 0x00020000
    s_cmp_eq_u32 s60, 1
    s_cbranch_scc1 KV_w3
    s_cmp_lg_u32 s2, 0
    s_cbranch_scc1 KV_notag
    s_memrealtime s[14:15]
    s_waitcnt lgkmcnt(0)
    s_or_b32 s14, s14, 1
    v_mov_b32 v30, s14
    v_mov_b32 v31, s15
    s_mov_b64 exec, 1
    buffer_store_dwordx2 v[30:31], v28, s[36:39], 0 offen sc1
    s_mov_b64 exec, -1
KV_notag:
    s_cmp_lg_u32 s43, 0
    s_cbranch_scc1 KV_norg
    s_mov_b32 m0, 131072
    s_mov_b32 s64, s16
    s_mov_b32 s65, s17
    s_mov_b32 s66, 0x800
    s_mov_b32 s67, 0x00020000
    s_mov_b32 s68, s24
    s_mov_b32 s69, s25
    s_mov_b32 s70, 0x800
    s_mov_b32 s71, 0x00020000
    buffer_load_dwordx4 v3, s[64:67], 0 offen lds
    buffer_load_dwordx4 v3, s[64:67], 0 offen offset:1024 lds
    s_mov_b32 m0, 133120
    s_nop 0
    buffer_load_dwordx4 v3, s[68:71], 0 offen lds
    buffer_load_dwordx4 v3, s[68:71], 0 offen offset:1024 lds
KV_norg:
    s_lshl_b32 s57, s2, 12
    s_add_u32 s57, s57, 11534336
    buffer_store_dwordx4 v[24:27], v3, s[32:35], s57 offen offset:0 sc1
    buffer_store_dwordx4 v[24:27], v3, s[32:35], s57 offen offset:1024 sc1
    buffer_store_dwordx4 v[24:27], v3, s[32:35], s57 offen offset:2048 sc1
    buffer_store_dwordx4 v[24:27], v3, s[32:35], s57 offen offset:3072 sc1
    s_waitcnt vmcnt(4)
    s_branch KV_go
KV_w3:
    s_getpc_b64 s[50:51]
KV_pc:
    v_lshlrev_b32 v29, 6, v1
    global_load_dword v32, v29, s[50:51]
    v_add_u32 v29, 0x1000, v29
    global_load_dword v33, v29, s[50:51]
    v_add_u32 v29, 0x1000, v29
    global_load_dword v34, v29, s[50:51]
    v_add_u32 v29, 0x1000, v29
    v_min_u32 v29, K_fallback-KV_pc, v29
    global_load_dword v35, v29, s[50:51]
    v_add_u32 v29, 0x1000, v29
    v_min_u32 v29, K_fallback-KV_pc, v29
    global_load_dword v38, v29, s[50:51]
    v_mov_b32 v29, 0
    v_mov_b32 v30, 0
    v_mov_b32 v31, 0
    v_add_u32 v22, 151680, v3
    v_mov_b32 v21, 152704
    ds_write_b128 v22, v[28:31]
    ds_write_b128 v21, v[28:31]
    s_waitcnt lgkmcnt(0)
    s_lshl_b32 s57, s2, 11
    s_add_u32 s57, s57, 11010048
    buffer_store_dwordx4 v[24:27], v3, s[32:35], s57 offen sc1
    buffer_store_dwordx4 v[24:27], v3, s[32:35], s57 offen offset:1024 sc1
    v_lshlrev_b32 v29, 2, v1
    s_lshl_b32 s57, s2, 8
    s_add_u32 s57, s57, 10846208
    buffer_store_dword v24, v29, s[32:35], s57 offen sc1
KV_go:
    v_and_b32 v10, 15, v1
    v_lshrrev_b32 v11, 4, v1
    v_xor_b32 v12, v10, v11
    v_lshlrev_b32 v12, 4, v12
    v_lshl_add_u32 v4, v10, 9, v12
    v_xor_b32 v5, 64, v4
    v_xor_b32 v6, 128, v4
    v_xor_b32 v7, 192, v4
    v_bfe_u32 v12, v1, 2, 2
    v_lshl_add_u32 v12, v11, 3, v12
    v_lshlrev_b32 v12, 6, v12
    v_and_b32 v13, 3, v1
    v_lshl_add_u32 v12, v13, 3, v12
    s_lshl_b32 s57, s60, 5
    s_add_u32 s57, s57, 0x2000
    v_add_u32 v8, s57, v12
    v_and_b32 v12, 1, v1
    v_lshlrev_b32 v12, 11, v12
    v_lshl_add_u32 v12, v11, 4, v12
    v_add_u32 v9, 131072, v12
    v_mov_b32 v16, 0
    v_mov_b32 v17, 0
    v_mov_b32 v18, 0
    v_mov_b32 v19, 0
    v_mov_b32 v20, 0
    v_mov_b32 v21, 0
    v_mov_b32 v22, 0
    v_mov_b32 v23, 0
    s_mov_b32 s49, 0
    s_cmp_lg_u32 s43, 0
    s_cbranch_scc1 KV_vloop
    s_cmp_lg_u32 s60, 0
    s_cbranch_scc1 KV_kloop
KV_rloop:
    s_waitcnt lgkmcnt(0)
    s_barrier
    ds_read_b128 v[48:51], v4 offset:0
    ds_read_b64_tr_b16 v[80:81], v8 offset:0
    ds_read_b64_tr_b16 v[82:83], v8 offset:256
    ds_read_b128 v[112:115], v9 offset:0
    ds_read_b128 v[52:55], v5 offset:0
    ds_read_b64_tr_b16 v[84:85], v8 offset:2048
    ds_read_b64_tr_b16 v[86:87], v8 offset:2304
    ds_read_b128 v[116:119], v9 offset:64
    ds_read_b128 v[56:59], v6 offset:0
    ds_read_b64_tr_b16 v[88:89], v8 offset:4096
    ds_read_b64_tr_b16 v[90:91], v8 offset:4352
    ds_read_b128 v[120:123], v9 offset:128
    s_waitcnt lgkmcnt(8)
    v_mfma_f32_16x16x32_bf16 v[16:19], v[80:83], v[48:51], v[16:19]
    v_mfma_f32_16x16x32_bf16 v[20:23], v[112:115], v[48:51], v[20:23]
    ds_read_b128 v[60:63], v7 offset:0
    ds_read_b64_tr_b16 v[92:93], v8 offset:6144
    ds_read_b64_tr_b16 v[94:95], v8 offset:6400
    ds_read_b128 v[124:127], v9 offset:192
    s_waitcnt lgkmcnt(8)
    v_mfma_f32_16x16x32_bf16 v[16:19], v[84:87], v[52:55], v[16:19]
    v_mfma_f32_16x16x32_bf16 v[20:23], v[116:119], v[52:55], v[20:23]
    ds_read_b128 v[64:67], v4 offset:256
    ds_read_b64_tr_b16 v[96:97], v8 offset:8192
    ds_read_b64_tr_b16 v[98:99], v8 offset:8448
    ds_read_b128 v[128:131], v9 offset:256
    s_waitcnt lgkmcnt(8)
    v_mfma_f32_16x16x32_bf16 v[16:19], v[88:91], v[56:59], v[16:19]
    v_mfma_f32_16x16x32_bf16 v[20:23], v[120:123], v[56:59], v[20:23]
    ds_read_b128 v[68:71], v5 offset:256
    ds_read_b64_tr_b16 v[100:101], v8 offset:10240
    ds_read_b64_tr_b16 v[102:103], v8 offset:10496
    ds_read_b128 v[132:135], v9 offset:320
    s_waitcnt lgkmcnt(8)
    v_mfma_f32_16x16x32_bf16 v[16:19], v[92:95], v[60:63], v[16:19]
    v_mfma_f32_16x16x32_bf16 v[20:23], v[124:127], v[60:63], v[20:23]
    ds_read_b128 v[72:75], v6 offset:256
    ds_read_b64_tr_b16 v[104:105], v8 offset:12288
    ds_read_b64_tr_b16 v[106:107], v8 offset:12544
    ds_read_b128 v[136:139], v9 offset:384
    s_waitcnt lgkmcnt(8)
    v_mfma_f32_16x16x32_bf16 v[16:19], v[96:99], v[64:67], v[16:19]
    v_mfma_f32_16x16x32_bf16 v[20:23], v[128:131], v[64:67], v[20:23]
    ds_read_b128 v[76:79], v7 offset:256
    ds_read_b64_tr_b16 v[108:109], v8 offset:14336
    ds_read_b64_tr_b16 v[110:111], v8 offset:14592
    ds_read_b128 v[140:143], v9 offset:448
    v_add_u32 v4, 24576, v4
    v_add_u32 v5, 24576, v5
    v_add_u32 v6, 24576, v6
    v_add_u32 v7, 24576, v7
    v_add_u32 v8, 24576, v8
    v_add_u32 v9, 512, v9
    s_add_u32 s49, s49, 1
    s_cmp_lt_u32 s49, 4
    s_waitcnt lgkmcnt(8)
    v_mfma_f32_16x16x32_bf16 v[16:19], v[100:103], v[68:71], v[16:19]
    v_mfma_f32_16x16x32_bf16 v[20:23], v[132:135], v[68:71], v[20:23]
    s_waitcnt lgkmcnt(4)
    v_mfma_f32_16x16x32_bf16 v[16:19], v[104:107], v[72:75], v[16:19]
    v_mfma_f32_16x16x32_bf16 v[20:23], v[136:139], v[72:75], v[20:23]
    s_waitcnt lgkmcnt(0)
    v_mfma_f32_16x16x32_bf16 v[16:19], v[108:111], v[76:79], v[16:19]
    v_mfma_f32_16x16x32_bf16 v[20:23], v[140:143], v[76:79], v[20:23]
    s_cbranch_scc1 KV_rloop
    s_branch KV_store
KV_kloop:
    s_waitcnt lgkmcnt(0)
    s_barrier
    ds_read_b128 v[48:51], v4 offset:0
    ds_read_b64_tr_b16 v[80:81], v8 offset:0
    ds_read_b64_tr_b16 v[82:83], v8 offset:256
    ds_read_b128 v[52:55], v5 offset:0
    ds_read_b64_tr_b16 v[84:85], v8 offset:2048
    ds_read_b64_tr_b16 v[86:87], v8 offset:2304
    ds_read_b128 v[56:59], v6 offset:0
    ds_read_b64_tr_b16 v[88:89], v8 offset:4096
    ds_read_b64_tr_b16 v[90:91], v8 offset:4352
    s_waitcnt lgkmcnt(6)
    v_mfma_f32_16x16x32_bf16 v[16:19], v[80:83], v[48:51], v[16:19]
    ds_read_b128 v[60:63], v7 offset:0
    ds_read_b64_tr_b16 v[92:93], v8 offset:6144
    ds_read_b64_tr_b16 v[94:95], v8 offset:6400
    s_waitcnt lgkmcnt(6)
    v_mfma_f32_16x16x32_bf16 v[16:19], v[84:87], v[52:55], v[16:19]
    ds_read_b128 v[64:67], v4 offset:256
    ds_read_b64_tr_b16 v[96:97], v8 offset:8192
    ds_read_b64_tr_b16 v[98:99], v8 offset:8448
    s_waitcnt lgkmcnt(6)
    v_mfma_f32_16x16x32_bf16 v[16:19], v[88:91], v[56:59], v[16:19]
    ds_read_b128 v[68:71], v5 offset:256
    ds_read_b64_tr_b16 v[100:101], v8 offset:10240
    ds_read_b64_tr_b16 v[102:103], v8 offset:10496
    s_waitcnt lgkmcnt(6)
    v_mfma_f32_16x16x32_bf16 v[16:19], v[92:95], v[60:63], v[16:19]
    ds_read_b128 v[72:75], v6 offset:256
    ds_read_b64_tr_b16 v[104:105], v8 offset:12288
    ds_read_b64_tr_b16 v[106:107], v8 offset:12544
    s_waitcnt lgkmcnt(6)
    v_mfma_f32_16x16x32_bf16 v[16:19], v[96:99], v[64:67], v[16:19]
    ds_read_b128 v[76:79], v7 offset:256
    ds_read_b64_tr_b16 v[108:109], v8 offset:14336
    ds_read_b64_tr_b16 v[110:111], v8 offset:14592
    v_add_u32 v4, 24576, v4
    v_add_u32 v5, 24576, v5
    v_add_u32 v6, 24576, v6
    v_add_u32 v7, 24576, v7
    v_add_u32 v8, 24576, v8
    v_add_u32 v9, 512, v9
    s_add_u32 s49, s49, 1
    s_cmp_lt_u32 s49, 4
    s_waitcnt lgkmcnt(6)
    v_mfma_f32_16x16x32_bf16 v[16:19], v[100:103], v[68:71], v[16:19]
    s_waitcnt lgkmcnt(3)
    v_mfma_f32_16x16x32_bf16 v[16:19], v[104:107], v[72:75], v[16:19]
    s_waitcnt lgkmcnt(0)
    v_mfma_f32_16x16x32_bf16 v[16:19], v[108:111], v[76:79], v[16:19]
    s_cbranch_scc1 KV_kloop
    s_branch KV_store
KV_vloop:
    s_waitcnt lgkmcnt(0)
    s_barrier
    ds_read_b128 v[48:51], v4 offset:0
    ds_read_b64_tr_b16 v[80:81], v8 offset:0
    ds_read_b64_tr_b16 v[82:83], v8 offset:256
    ds_read_b128 v[52:55], v5 offset:0
    ds_read_b64_tr_b16 v[84:85], v8 offset:2048
    ds_read_b64_tr_b16 v[86:87], v8 offset:2304
    ds_read_b128 v[56:59], v6 offset:0
    ds_read_b64_tr_b16 v[88:89], v8 offset:4096
    ds_read_b64_tr_b16 v[90:91], v8 offset:4352
    s_waitcnt lgkmcnt(6)
    v_mfma_f32_16x16x32_bf16 v[16:19], v[48:51], v[80:83], v[16:19]
    ds_read_b128 v[60:63], v7 offset:0
    ds_read_b64_tr_b16 v[92:93], v8 offset:6144
    ds_read_b64_tr_b16 v[94:95], v8 offset:6400
    s_waitcnt lgkmcnt(6)
    v_mfma_f32_16x16x32_bf16 v[16:19], v[52:55], v[84:87], v[16:19]
    ds_read_b128 v[64:67], v4 offset:256
    ds_read_b64_tr_b16 v[96:97], v8 offset:8192
    ds_read_b64_tr_b16 v[98:99], v8 offset:8448
    s_waitcnt lgkmcnt(6)
    v_mfma_f32_16x16x32_bf16 v[16:19], v[56:59], v[88:91], v[16:19]
    ds_read_b128 v[68:71], v5 offset:256
    ds_read_b64_tr_b16 v[100:101], v8 offset:10240
    ds_read_b64_tr_b16 v[102:103], v8 offset:10496
    s_waitcnt lgkmcnt(6)
    v_mfma_f32_16x16x32_bf16 v[16:19], v[60:63], v[92:95], v[16:19]
    ds_read_b128 v[72:75], v6 offset:256
    ds_read_b64_tr_b16 v[104:105], v8 offset:12288
    ds_read_b64_tr_b16 v[106:107], v8 offset:12544
    s_waitcnt lgkmcnt(6)
    v_mfma_f32_16x16x32_bf16 v[16:19], v[64:67], v[96:99], v[16:19]
    ds_read_b128 v[76:79], v7 offset:256
    ds_read_b64_tr_b16 v[108:109], v8 offset:14336
    ds_read_b64_tr_b16 v[110:111], v8 offset:14592
    v_add_u32 v4, 24576, v4
    v_add_u32 v5, 24576, v5
    v_add_u32 v6, 24576, v6
    v_add_u32 v7, 24576, v7
    v_add_u32 v8, 24576, v8
    v_add_u32 v9, 512, v9
    s_add_u32 s49, s49, 1
    s_cmp_lt_u32 s49, 4
    s_waitcnt lgkmcnt(6)
    v_mfma_f32_16x16x32_bf16 v[16:19], v[68:71], v[100:103], v[16:19]
    s_waitcnt lgkmcnt(3)
    v_mfma_f32_16x16x32_bf16 v[16:19], v[72:75], v[104:107], v[16:19]
    s_waitcnt lgkmcnt(0)
    v_mfma_f32_16x16x32_bf16 v[16:19], v[76:79], v[108:111], v[16:19]
    s_cbranch_scc1 KV_vloop
KV_store:
    buffer_load_dwordx2 v[30:31], v28, s[36:39], 0 offen sc1
    v_and_b32 v12, 1, v11
    v_lshl_add_u32 v12, v12, 5, v10
    v_lshlrev_b32 v12, 4, v12
    v_lshrrev_b32 v13, 1, v11
    v_lshl_add_u32 v12, v13, 3, v12
    s_and_b32 s54, s44, 1
    s_cmp_eq_u32 s43, 0
    s_cselect_b32 s55, s60, s54
    s_cselect_b32 s56, s54, s60
    s_lshl_b32 s55, s55, 10
    s_lshl_b32 s56, s56, 8
    s_add_u32 s55, s55, s56
    s_lshl_b32 s56, s43, 11
    s_add_u32 s55, s55, s56
    s_lshl_b32 s56, s40, 1
    s_lshr_b32 s57, s44, 1
    s_add_u32 s56, s56, s57
    s_lshl_b32 s56, s56, 12
    s_add_u32 s55, s55, s56
    s_add_u32 s55, s55, 10485760
    s_cmp_eq_u32 s43, 0
    s_cselect_b32 s56, 0x3e8293ee, 1.0
    v_mul_f32 v16, s56, v16
    v_mul_f32 v17, s56, v17
    v_mul_f32 v18, s56, v18
    v_mul_f32 v19, s56, v19
    v_cvt_pk_bf16_f32 v14, v16, v17
    v_cvt_pk_bf16_f32 v15, v18, v19
    buffer_store_dwordx2 v[14:15], v12, s[32:35], s55 offen sc1
    s_or_b32 s54, s43, s60
    s_cmp_lg_u32 s54, 0
    s_cbranch_scc1 KV_nokey
    s_mov_b64 exec, 0xffff
    s_lshl_b32 s57, s40, 6
    s_lshl_b32 s56, s44, 4
    s_add_u32 s57, s57, s56
    v_add_u32 v12, s57, v1
    v_cvt_pk_bf16_f32 v36, v20, v20
    v_mul_f32 v21, 0xbfb8aa3b, v21
    v_and_b32 v36, 0xffff0000, v36
    v_exp_f32 v21, v21
    v_ashrrev_i32 v37, 31, v36
    v_or_b32 v37, 0x80000000, v37
    v_add_f32 v21, 1.0, v21
    v_xor_b32 v36, v36, v37
    v_rcp_f32 v21, v21
    v_and_b32 v36, 0xffff0000, v36
    v_sub_u32 v37, 2047, v12
    v_or_b32 v36, v36, v37
    v_lshlrev_b32 v12, 2, v12
    s_mov_b32 s57, 10813440
    s_mov_b32 s58, 10821632
    buffer_store_dword v36, v12, s[32:35], s57 offen sc1
    buffer_store_dword v21, v12, s[32:35], s58 offen sc1
    s_mov_b64 exec, -1
KV_nokey:
    s_barrier
    s_barrier
    s_barrier
    s_mov_b32 s49, 0
KV_tag:
    s_waitcnt vmcnt(0)
    v_readfirstlane_b32 s14, v30
    v_readfirstlane_b32 s15, v31
    s_add_u32 s49, s49, 1
    s_cmp_lg_u32 s14, 0
    s_cbranch_scc1 KV_havetag
    s_cmp_ge_u32 s49, 131072
    s_cbranch_scc1 KV_havetag
    buffer_load_dwordx2 v[30:31], v28, s[36:39], 0 offen sc1
    s_branch KV_tag
KV_havetag:
    s_lshl_b32 s57, s40, 7
    s_lshl_b32 s56, s41, 4
    s_add_u32 s57, s57, s56
    s_lshl_b32 s56, s60, 3
    s_add_u32 s57, s57, s56
    s_add_u32 s57, s57, 10829824
    s_mov_b64 exec, 1
    buffer_store_dwordx2 v[30:31], v28, s[32:35], s57 offen sc1
    s_mov_b64 exec, -1
    s_cmp_eq_u32 s60, 1
    s_cbranch_scc1 KV_ring
    v_bfe_u32 v8, v1, 2, 2
    v_lshl_add_u32 v12, v11, 3, v8
    v_lshlrev_b32 v12, 7, v12
    v_and_b32 v9, 3, v1
    v_lshl_add_u32 v12, v9, 3, v12
    v_and_b32 v10, 7, v1
    v_mul_u32_u24 v13, 528, v10
    v_lshl_add_u32 v13, v11, 4, v13
    v_add_u32 v13, 147456, v13
    v_lshl_add_u32 v11, v11, 3, v10
    v_lshlrev_b32 v11, 4, v11
    v_mov_b32 v16, 0
    v_mov_b32 v17, 0
    v_mov_b32 v18, 0
    v_mov_b32 v19, 0
    v_mov_b32 v20, 0
    v_mov_b32 v21, 0
    v_mov_b32 v22, 0
    v_mov_b32 v23, 0
    v_mov_b32 v24, 0
    v_mov_b32 v25, 0
    v_mov_b32 v26, 0
    v_mov_b32 v27, 0
    v_mov_b32 v28, 0
    v_mov_b32 v29, 0
    v_mov_b32 v30, 0
    v_mov_b32 v31, 0
    v_mov_b32 v32, 0
    v_mov_b32 v33, 0
    v_mov_b32 v34, 0
    v_mov_b32 v35, 0
    v_mov_b32 v36, 0
    v_mov_b32 v37, 0
    v_mov_b32 v38, 0
    v_mov_b32 v39, 0
    v_mov_b32 v40, 0
    v_mov_b32 v41, 0
    v_mov_b32 v42, 0
    v_mov_b32 v43, 0
    v_mov_b32 v44, 0
    v_mov_b32 v45, 0
    v_mov_b32 v46, 0
    v_mov_b32 v47, 0
    s_mov_b32 s50, 10829824
    s_mov_b32 s63, 0
    s_barrier
    s_barrier
    s_barrier
    s_barrier
    s_barrier
    s_barrier
    s_barrier
    s_barrier
    s_barrier
    s_barrier
    s_barrier
    buffer_load_dwordx4 v[96:99], v3, s[32:35], s50 offen offset:0 sc1
    buffer_load_dwordx4 v[100:103], v3, s[32:35], s50 offen offset:1024 sc1
    buffer_load_dwordx4 v[104:107], v3, s[32:35], s50 offen offset:2048 sc1
    buffer_load_dwordx4 v[108:111], v3, s[32:35], s50 offen offset:3072 sc1
    s_barrier
    s_barrier
    s_barrier
S1_chk:
    s_add_u32 s63, s63, 1
    s_waitcnt vmcnt(0)
    v_xor_b32 v96, s14, v96
    v_xor_b32 v97, s15, v97
    v_xor_b32 v98, s14, v98
    v_xor_b32 v99, s15, v99
    v_xor_b32 v100, s14, v100
    v_xor_b32 v101, s15, v101
    v_xor_b32 v102, s14, v102
    v_xor_b32 v103, s15, v103
    v_xor_b32 v104, s14, v104
    v_xor_b32 v105, s15, v105
    v_xor_b32 v106, s14, v106
    v_xor_b32 v107, s15, v107
    v_xor_b32 v108, s14, v108
    v_xor_b32 v109, s15, v109
    v_xor_b32 v110, s14, v110
    v_xor_b32 v111, s15, v111
    v_or3_b32 v96, v96, v97, v98
    v_or3_b32 v96, v99, v100, v96
    v_or3_b32 v96, v101, v102, v96
    v_or3_b32 v96, v103, v104, v96
    v_or3_b32 v96, v105, v106, v96
    v_or3_b32 v96, v107, v108, v96
    v_or3_b32 v96, v109, v110, v96
    v_or_b32 v96, v111, v96
    v_cmp_ne_u32 vcc, 0, v96
    s_cmp_ge_u32 s63, 131072
    s_cbranch_scc1 S1_ok
    s_cbranch_vccz S1_ok
    s_sleep 4
    buffer_load_dwordx4 v[96:99], v3, s[32:35], s50 offen offset:0 sc1
    buffer_load_dwordx4 v[100:103], v3, s[32:35], s50 offen offset:1024 sc1
    buffer_load_dwordx4 v[104:107], v3, s[32:35], s50 offen offset:2048 sc1
    buffer_load_dwordx4 v[108:111], v3, s[32:35], s50 offen offset:3072 sc1
    s_branch S1_chk
S1_ok:
    v_mov_b32 v14, 1
    v_mov_b32 v15, 152716
    ds_write_b32 v15, v14
    s_branch K_A2
KV_ring:
    s_lshr_b32 s46, s40, 3
    s_lshl_b32 s50, s46, 10
    s_add_u32 s50, s50, 10829824
    s_lshl_b32 s46, s46, 16
    s_add_u32 s46, s46, 10485760
    s_mov_b32 s45, 98304
    v_and_b32 v20, 3, v1
    v_lshlrev_b32 v20, 8, v20
    v_add_u32 v20, 151680, v20
    v_mov_b32 v21, 152704
    s_barrier
    s_barrier
    s_barrier
    s_barrier
    s_barrier
    s_barrier
    s_barrier
    s_barrier
    buffer_load_dwordx4 v[32:35], v3, s[32:35], s50 offen offset:0 sc1
    s_barrier
    s_barrier
    s_waitcnt vmcnt(0)
    v_xor_b32 v32, s14, v32
    v_xor_b32 v33, s15, v33
    v_xor_b32 v34, s14, v34
    v_xor_b32 v35, s15, v35
    v_or3_b32 v32, v32, v33, v34
    v_or_b32 v32, v35, v32
    v_cmp_ne_u32 vcc, 0, v32
    s_mov_b32 s63, 0
    s_mov_b32 s49, 0
    s_cbranch_vccnz KV_late
    s_barrier
KV_first2:
    s_add_u32 m0, s45, 0
    s_nop 0
    buffer_load_dwordx4 v3, s[32:35], s46 offen offset:0 sc1 lds
    buffer_load_dwordx4 v3, s[32:35], s46 offen offset:1024 sc1 lds
    buffer_load_dwordx4 v3, s[32:35], s46 offen offset:2048 sc1 lds
    buffer_load_dwordx4 v3, s[32:35], s46 offen offset:3072 sc1 lds
    s_add_u32 s46, s46, 0x1000
    s_add_u32 m0, s45, 4096
    s_nop 0
    buffer_load_dwordx4 v3, s[32:35], s46 offen offset:0 sc1 lds
    buffer_load_dwordx4 v3, s[32:35], s46 offen offset:1024 sc1 lds
    buffer_load_dwordx4 v3, s[32:35], s46 offen offset:2048 sc1 lds
    buffer_load_dwordx4 v3, s[32:35], s46 offen offset:3072 sc1 lds
    s_add_u32 s46, s46, 0x1000
    s_add_u32 m0, s45, 8192
    s_nop 0
    buffer_load_dwordx4 v3, s[32:35], s46 offen offset:0 sc1 lds
    buffer_load_dwordx4 v3, s[32:35], s46 offen offset:1024 sc1 lds
    buffer_load_dwordx4 v3, s[32:35], s46 offen offset:2048 sc1 lds
    buffer_load_dwordx4 v3, s[32:35], s46 offen offset:3072 sc1 lds
    s_add_u32 s46, s46, 0x1000
    s_add_u32 m0, s45, 12288
    s_nop 0
    buffer_load_dwordx4 v3, s[32:35], s46 offen offset:0 sc1 lds
    buffer_load_dwordx4 v3, s[32:35], s46 offen offset:1024 sc1 lds
    buffer_load_dwordx4 v3, s[32:35], s46 offen offset:2048 sc1 lds
    buffer_load_dwordx4 v3, s[32:35], s46 offen offset:3072 sc1 lds
    s_add_u32 s46, s46, 0x1000
    s_cmp_eq_u32 s46, 10747904
    s_cselect_b32 s46, 10485760, s46
    s_add_u32 s45, s45, 16384
    s_add_u32 s49, s49, 1
    s_cmp_lg_u32 s63, 0
    s_cbranch_scc1 KV_nobar
    s_barrier
KV_nobar:
    s_cmp_lt_u32 s49, 2
    s_cbranch_scc1 KV_first2
    s_cmp_lg_u32 s63, 0
    s_cbranch_scc1 KV_run
    s_barrier
    s_branch KV_run
KV_late:
    s_barrier
    s_barrier
    s_barrier
    s_barrier
KV_latepoll:
    buffer_load_dwordx4 v[32:35], v3, s[32:35], s50 offen offset:0 sc1
    s_add_u32 s63, s63, 1
    s_waitcnt vmcnt(0)
    v_xor_b32 v32, s14, v32
    v_xor_b32 v33, s15, v33
    v_xor_b32 v34, s14, v34
    v_xor_b32 v35, s15, v35
    v_or3_b32 v32, v32, v33, v34
    v_or_b32 v32, v35, v32
    v_cmp_ne_u32 vcc, 0, v32
    s_cmp_ge_u32 s63, 131072
    s_cbranch_scc1 KV_first2
    s_cbranch_vccnz KV_latepoll
    s_branch KV_first2
KV_run:
    v_mov_b32 v22, 1
    s_waitcnt vmcnt(16)
    ds_write_b32 v21, v22
KV_run2:
    s_mov_b32 s45, 65536
KV_go2:
    s_cmp_lg_u32 s49, 4
    s_cbranch_scc1 KV_go3
    v_mov_b32 v15, 152716
KV_wS1:
    s_sleep 1
    ds_read_b32 v14, v15
    s_waitcnt lgkmcnt(0)
    v_readfirstlane_b32 s57, v14
    s_nop 0
    s_cmp_eq_u32 s57, 0
    s_cbranch_scc1 KV_wS1
KV_go3:
    ds_read_b32 v23, v20
    s_add_u32 m0, s45, 0
    s_nop 0
    buffer_load_dwordx4 v3, s[32:35], s46 offen offset:0 sc1 lds
    buffer_load_dwordx4 v3, s[32:35], s46 offen offset:1024 sc1 lds
    buffer_load_dwordx4 v3, s[32:35], s46 offen offset:2048 sc1 lds
    buffer_load_dwordx4 v3, s[32:35], s46 offen offset:3072 sc1 lds
    s_add_u32 s46, s46, 0x1000
    s_add_u32 m0, s45, 4096
    s_nop 0
    buffer_load_dwordx4 v3, s[32:35], s46 offen offset:0 sc1 lds
    buffer_load_dwordx4 v3, s[32:35], s46 offen offset:1024 sc1 lds
    buffer_load_dwordx4 v3, s[32:35], s46 offen offset:2048 sc1 lds
    buffer_load_dwordx4 v3, s[32:35], s46 offen offset:3072 sc1 lds
    s_add_u32 s46, s46, 0x1000
    s_add_u32 m0, s45, 8192
    s_nop 0
    buffer_load_dwordx4 v3, s[32:35], s46 offen offset:0 sc1 lds
    buffer_load_dwordx4 v3, s[32:35], s46 offen offset:1024 sc1 lds
    buffer_load_dwordx4 v3, s[32:35], s46 offen offset:2048 sc1 lds
    buffer_load_dwordx4 v3, s[32:35], s46 offen offset:3072 sc1 lds
    s_add_u32 s46, s46, 0x1000
    s_add_u32 m0, s45, 12288
    s_nop 0
    buffer_load_dwordx4 v3, s[32:35], s46 offen offset:0 sc1 lds
    buffer_load_dwordx4 v3, s[32:35], s46 offen offset:1024 sc1 lds
    buffer_load_dwordx4 v3, s[32:35], s46 offen offset:2048 sc1 lds
    buffer_load_dwordx4 v3, s[32:35], s46 offen offset:3072 sc1 lds
    s_add_u32 s46, s46, 0x1000
    s_cmp_eq_u32 s46, 10747904
    s_cselect_b32 s46, 10485760, s46
    s_add_u32 s45, s45, 16384
    s_cmp_eq_u32 s45, 131072
    s_cselect_b32 s45, 65536, s45
    v_mov_b32 v22, s49
    s_add_u32 s49, s49, 1
    s_waitcnt vmcnt(16) lgkmcnt(0)
    ds_write_b32 v21, v22
    v_readlane_b32 s58, v23, 0
    v_readlane_b32 s57, v23, 1
    v_readlane_b32 s56, v23, 2
    v_readlane_b32 s55, v23, 3
    s_min_u32 s58, s58, s57
    s_min_u32 s56, s56, s55
    s_min_u32 s58, s58, s56
    s_add_u32 s58, s58, 4
    s_min_u32 s58, s58, 16
    s_cmp_lt_u32 s49, s58
    s_cbranch_scc1 KV_go2
    s_cmp_ge_u32 s49, 16
    s_cbranch_scc1 KV_done
    v_mov_b32 v22, s49
    s_waitcnt vmcnt(0)
    ds_write_b32 v21, v22
KV_poll:
    s_sleep 8
    ds_read_b32 v23, v20
    s_waitcnt lgkmcnt(0)
    v_readlane_b32 s58, v23, 0
    v_readlane_b32 s57, v23, 1
    v_readlane_b32 s56, v23, 2
    v_readlane_b32 s55, v23, 3
    s_min_u32 s58, s58, s57
    s_min_u32 s56, s56, s55
    s_min_u32 s58, s58, s56
    s_add_u32 s58, s58, 4
    s_cmp_lt_u32 s49, s58
    s_cbranch_scc1 KV_go2
    s_branch KV_poll
KV_done:
    v_mov_b32 v22, 16
    s_waitcnt vmcnt(0)
    ds_write_b32 v21, v22
    s_waitcnt lgkmcnt(0)
    s_branch K_p3ld
K_comp:
    s_setprio 3
    s_sub_u32 s60, s42, 4
    v_and_b32 v15, 15, v1
    v_and_b32 v12, 31, v1
    v_lshrrev_b32 v14, 5, v1
    v_lshlrev_b32 v18, 7, v12
    v_lshrrev_b32 v19, 1, v12
    v_and_b32 v19, 7, v19
    v_xor_b32 v19, v19, v14
    v_lshl_add_u32 v8, v19, 4, v18
    v_lshrrev_b32 v18, 2, v15
    v_and_b32 v19, 3, v15
    v_lshl_add_u32 v20, v14, 3, v18
    v_bfe_u32 v21, v1, 4, 1
    s_lshl_b32 s53, s60, 2
    v_lshlrev_b32 v22, 1, v21
    v_lshrrev_b32 v23, 1, v19
    v_add3_u32 v22, v22, v23, s53
    v_lshlrev_b32 v23, 2, v18
    v_xor_b32 v22, v22, v23
    v_lshlrev_b32 v22, 4, v22
    v_lshl_add_u32 v22, v20, 8, v22
    v_and_b32 v23, 1, v19
    v_lshl_add_u32 v22, v23, 3, v22
    v_add_u32 v9, 0x2000, v22
    v_and_b32 v4, 1, v1
    v_mov_b32 v5, 0x4444
    v_mov_b32 v6, 0xeeee
    v_cmp_eq_u32 vcc, 1, v4
    v_and_b32 v4, 6, v1
    v_mov_b32 v7, 0x3f803f80
    v_cndmask_b32 v148, v5, v6, vcc
    v_cmp_eq_u32 vcc, 0, v4
    v_cmp_eq_u32 s[50:51], 4, v4
    s_lshl_b32 s52, s60, 8
    v_cndmask_b32 v144, 0, v7, vcc
    v_cndmask_b32 v145, 0, v7, vcc
    v_cndmask_b32 v146, 0, v7, s[50:51]
    v_cndmask_b32 v147, 0, v7, s[50:51]
    s_add_u32 s52, s52, 151680
    v_lshl_add_u32 v151, v1, 2, s52
    v_mov_b32 v152, 1
    v_mov_b32 v154, 152704
    v_add_u32 v149, 98304, v3
    v_add_u32 v150, 114688, v3
    s_mov_b32 s48, 114688
    v_mov_b32 v12, v8
    v_mov_b32 v16, v9
    v_xor_b32 v13, 32, v8
    v_xor_b32 v14, 64, v8
    v_xor_b32 v15, 0x60, v8
    s_mov_b32 s44, 0
    s_mov_b32 s49, 0
    s_waitcnt lgkmcnt(0)
    s_mov_b32 s32, s30
    s_mov_b32 s33, s31
    s_mov_b32 s34, 0xc00000
    s_mov_b32 s35, 0x00020000
    s_mov_b32 s36, s28
    s_mov_b32 s37, s29
    s_mov_b32 s38, 0x100
    s_mov_b32 s39, 0x00020000
    s_barrier
    v_mov_b32 v24, 0
    v_mov_b32 v25, 0
    v_mov_b32 v26, 0
    v_mov_b32 v27, 0
    v_mov_b32 v28, 0
    v_mov_b32 v29, 0
    v_mov_b32 v30, 0
    v_mov_b32 v31, 0
    v_mov_b32 v32, 0
    v_mov_b32 v33, 0
    v_mov_b32 v34, 0
    v_mov_b32 v35, 0
    v_mov_b32 v36, 0
    v_mov_b32 v37, 0
    v_mov_b32 v38, 0
    v_mov_b32 v39, 0
    v_mov_b32 v40, 0
    v_mov_b32 v41, 0
    v_mov_b32 v42, 0
    v_mov_b32 v43, 0
    v_mov_b32 v44, 0
    v_mov_b32 v45, 0
    v_mov_b32 v46, 0
    v_mov_b32 v47, 0
    v_mov_b32 v48, 0
    v_mov_b32 v49, 0
    v_mov_b32 v50, 0
    v_mov_b32 v51, 0
    v_mov_b32 v52, 0
    v_mov_b32 v53, 0
    v_mov_b32 v54, 0
    v_mov_b32 v55, 0
    v_mov_b32 v72, 0
    v_mov_b32 v73, 0
    v_mov_b32 v74, 0
    v_mov_b32 v75, 0
    v_mov_b32 v76, 0
    v_mov_b32 v77, 0
    v_mov_b32 v78, 0
    v_mov_b32 v79, 0
    v_mov_b32 v80, 0
    v_mov_b32 v81, 0
    v_mov_b32 v82, 0
    v_mov_b32 v83, 0
    v_mov_b32 v84, 0
    v_mov_b32 v85, 0
    v_mov_b32 v86, 0
    v_mov_b32 v87, 0
    v_mov_b32 v88, 0
    v_mov_b32 v89, 0
    v_mov_b32 v90, 0
    v_mov_b32 v91, 0
    v_mov_b32 v92, 0
    v_mov_b32 v93, 0
    v_mov_b32 v94, 0
    v_mov_b32 v95, 0
    v_mov_b32 v96, 0
    v_mov_b32 v97, 0
    v_mov_b32 v98, 0
    v_mov_b32 v99, 0
    v_mov_b32 v100, 0
    v_mov_b32 v101, 0
    v_mov_b32 v102, 0
    v_mov_b32 v103, 0
    v_mov_b32 v104, 0
    v_mov_b32 v105, 0
    v_mov_b32 v106, 0
    v_mov_b32 v107, 0
    v_mov_b32 v108, 0
    v_mov_b32 v109, 0
    v_mov_b32 v110, 0
    v_mov_b32 v111, 0
    s_barrier
    v_mov_b32 v64, 0
    v_mov_b32 v65, 0
    v_mov_b32 v66, 0
    v_mov_b32 v67, 0
    v_mov_b32 v68, 0
    v_mov_b32 v69, 0
    v_mov_b32 v70, 0
    v_mov_b32 v71, 0
    v_mov_b32 v136, 0
    v_mov_b32 v137, 0
    v_mov_b32 v138, 0
    v_mov_b32 v139, 0
    v_mov_b32 v140, 0
    v_mov_b32 v141, 0
    v_mov_b32 v142, 0
    v_mov_b32 v143, 0
    v_mov_b32 v208, 0
    v_mov_b32 v209, 0
    v_mov_b32 v210, 0
    v_mov_b32 v211, 0
    v_mov_b32 v212, 0
    v_mov_b32 v213, 0
    v_mov_b32 v214, 0
    v_mov_b32 v215, 0
    v_mov_b32 v216, 0
    v_mov_b32 v217, 0
    v_mov_b32 v218, 0
    v_mov_b32 v219, 0
    v_mov_b32 v220, 0
    v_mov_b32 v221, 0
    v_mov_b32 v222, 0
    v_mov_b32 v223, 0
    v_mov_b32 v224, 0
    v_mov_b32 v225, 0
    v_mov_b32 v226, 0
    v_mov_b32 v227, 0
    v_mov_b32 v228, 0
    v_mov_b32 v229, 0
    v_mov_b32 v230, 0
    v_mov_b32 v231, 0
    v_mov_b32 v232, 0
    v_mov_b32 v233, 0
    v_mov_b32 v234, 0
    v_mov_b32 v235, 0
    v_mov_b32 v236, 0
    v_mov_b32 v237, 0
    v_mov_b32 v238, 0
    v_mov_b32 v239, 0
    v_mov_b32 v240, 0
    v_mov_b32 v241, 0
    v_mov_b32 v242, 0
    v_mov_b32 v243, 0
    v_mov_b32 v244, 0
    v_mov_b32 v245, 0
    v_mov_b32 v246, 0
    v_mov_b32 v247, 0
    v_mov_b32 v248, 0
    v_mov_b32 v249, 0
    v_mov_b32 v250, 0
    v_mov_b32 v251, 0
    v_mov_b32 v252, 0
    v_mov_b32 v253, 0
    v_mov_b32 v254, 0
    v_mov_b32 v255, 0
    s_barrier
    s_barrier
P1_loop:
    s_barrier
    ds_read_b128 v[160:163], v12
    ds_read_b64_tr_b16 v[192:193], v16 offset:0
    ds_read_b64_tr_b16 v[194:195], v16 offset:1024
    v_mfma_f32_32x32x16_bf16 v[24:39], v[240:243], v[208:211], v[24:39]
    ds_read_b128 v[176:179], v12 offset:4096
    ds_read_b128 v[164:167], v13
    v_mfma_f32_32x32x16_bf16 v[40:55], v[240:243], v[224:227], v[40:55]
    ds_read_b64_tr_b16 v[196:197], v16 offset:4096
    ds_read_b64_tr_b16 v[198:199], v16 offset:5120
    ds_read_b128 v[180:183], v13 offset:4096
    v_mfma_f32_32x32x16_bf16 v[24:39], v[244:247], v[212:215], v[24:39]
    ds_read_b128 v[168:171], v14
    ds_read_b64_tr_b16 v[200:201], v16 offset:8192
    ds_read_b64_tr_b16 v[202:203], v16 offset:9216
    v_mfma_f32_32x32x16_bf16 v[40:55], v[244:247], v[228:231], v[40:55]
    ds_read_b128 v[184:187], v14 offset:4096
    ds_read_b128 v[172:175], v15
    s_waitcnt lgkmcnt(8)
    v_mfma_f32_32x32x16_bf16 v[24:39], v[248:251], v[216:219], v[24:39]
    ds_read_b64_tr_b16 v[204:205], v16 offset:12288
    ds_read_b64_tr_b16 v[206:207], v16 offset:13312
    ds_read_b128 v[188:191], v15 offset:4096
    v_mfma_f32_32x32x16_bf16 v[40:55], v[248:251], v[232:235], v[40:55]
    v_mfma_f32_32x32x16_bf16 v[24:39], v[252:255], v[220:223], v[24:39]
    s_add_u32 s44, s44, 24576
    s_cmp_eq_u32 s44, 98304
    s_cselect_b32 s44, 0, s44
    v_add_u32 v12, s44, v8
    v_add_u32 v16, s44, v9
    v_mfma_f32_32x32x16_bf16 v[40:55], v[252:255], v[236:239], v[40:55]
    v_xor_b32 v13, 32, v12
    v_xor_b32 v14, 64, v12
    v_xor_b32 v15, 0x60, v12
    s_add_u32 s49, s49, 1
    s_waitcnt lgkmcnt(0)
    s_barrier
    ds_read_b128 v[208:211], v12
    ds_read_b64_tr_b16 v[240:241], v16 offset:0
    ds_read_b64_tr_b16 v[242:243], v16 offset:1024
    v_mfma_f32_32x32x16_bf16 v[24:39], v[192:195], v[160:163], v[24:39]
    ds_read_b128 v[224:227], v12 offset:4096
    ds_read_b128 v[212:215], v13
    v_mfma_f32_32x32x16_bf16 v[40:55], v[192:195], v[176:179], v[40:55]
    ds_read_b64_tr_b16 v[244:245], v16 offset:4096
    ds_read_b64_tr_b16 v[246:247], v16 offset:5120
    ds_read_b128 v[228:231], v13 offset:4096
    v_mfma_f32_32x32x16_bf16 v[24:39], v[196:199], v[164:167], v[24:39]
    ds_read_b128 v[216:219], v14
    ds_read_b64_tr_b16 v[248:249], v16 offset:8192
    ds_read_b64_tr_b16 v[250:251], v16 offset:9216
    v_mfma_f32_32x32x16_bf16 v[40:55], v[196:199], v[180:183], v[40:55]
    ds_read_b128 v[232:235], v14 offset:4096
    ds_read_b128 v[220:223], v15
    s_waitcnt lgkmcnt(8)
    v_mfma_f32_32x32x16_bf16 v[24:39], v[200:203], v[168:171], v[24:39]
    ds_read_b64_tr_b16 v[252:253], v16 offset:12288
    ds_read_b64_tr_b16 v[254:255], v16 offset:13312
    ds_read_b128 v[236:239], v15 offset:4096
    v_mfma_f32_32x32x16_bf16 v[40:55], v[200:203], v[184:187], v[40:55]
    v_mfma_f32_32x32x16_bf16 v[24:39], v[204:207], v[172:175], v[24:39]
    s_add_u32 s44, s44, 24576
    s_cmp_eq_u32 s44, 98304
    s_cselect_b32 s44, 0, s44
    v_add_u32 v12, s44, v8
    v_add_u32 v16, s44, v9
    v_mfma_f32_32x32x16_bf16 v[40:55], v[204:207], v[188:191], v[40:55]
    v_xor_b32 v13, 32, v12
    v_xor_b32 v14, 64, v12
    v_xor_b32 v15, 0x60, v12
    s_add_u32 s49, s49, 1
    s_waitcnt lgkmcnt(0)
    s_cmp_lt_u32 s49, 16
    s_cbranch_scc1 P1_loop
    s_barrier
    v_mfma_f32_32x32x16_bf16 v[24:39], v[240:243], v[208:211], v[24:39]
    v_mfma_f32_32x32x16_bf16 v[24:39], v[244:247], v[212:215], v[24:39]
    v_mfma_f32_32x32x16_bf16 v[24:39], v[248:251], v[216:219], v[24:39]
    v_mfma_f32_32x32x16_bf16 v[24:39], v[252:255], v[220:223], v[24:39]
    v_mfma_f32_32x32x16_bf16 v[40:55], v[240:243], v[224:227], v[40:55]
    v_mfma_f32_32x32x16_bf16 v[40:55], v[244:247], v[228:231], v[40:55]
    v_mfma_f32_32x32x16_bf16 v[40:55], v[248:251], v[232:235], v[40:55]
    v_mfma_f32_32x32x16_bf16 v[40:55], v[252:255], v[236:239], v[40:55]
    s_lshl_b32 s45, s40, 6
    s_lshl_b32 s46, s41, 2
    s_add_u32 s45, s45, s46
    s_add_u32 s45, s45, s60
    s_lshl_b32 s45, s45, 11
    s_add_u32 s46, s45, 0x10000
    s_mov_b32 s49, 2
K_first:
    ds_read_b32 v4, v154
    s_waitcnt vmcnt(0) lgkmcnt(0)
    v_readfirstlane_b32 s47, v4
    s_nop 0
    s_cmp_lg_u32 s47, 0
    s_cbranch_scc0 K_first
    ds_read_b128 v[112:115], v149
    ds_read_b128 v[116:119], v149 offset:1024
    ds_read_b128 v[120:123], v149 offset:4096
    ds_read_b128 v[124:127], v149 offset:5120
    ds_read_b128 v[128:131], v149 offset:2048
    ds_read_b128 v[132:135], v149 offset:3072
    v_cvt_pk_bf16_f32 v8, v24, v25
    v_cvt_pk_bf16_f32 v9, v26, v27
    v_cvt_pk_bf16_f32 v10, v28, v29
    v_cvt_pk_bf16_f32 v11, v30, v31
    v_cvt_pk_bf16_f32 v12, v32, v33
    v_cvt_pk_bf16_f32 v13, v34, v35
    v_cvt_pk_bf16_f32 v14, v36, v37
    v_cvt_pk_bf16_f32 v15, v38, v39
    s_waitcnt lgkmcnt(0)
    s_nop 0
    v_mfma_f32_32x32x16_bf16 v[24:39], v[112:115], v[8:11], 0
    v_mfma_f32_32x32x16_bf16 v[24:39], v[116:119], v[12:15], v[24:39]
    v_cvt_pk_bf16_f32 v16, v40, v41
    v_cvt_pk_bf16_f32 v17, v42, v43
    v_cvt_pk_bf16_f32 v18, v44, v45
    v_cvt_pk_bf16_f32 v19, v46, v47
    v_cvt_pk_bf16_f32 v20, v48, v49
    v_cvt_pk_bf16_f32 v21, v50, v51
    v_cvt_pk_bf16_f32 v22, v52, v53
    v_cvt_pk_bf16_f32 v23, v54, v55
    v_and_b32 v4, 31, v1
    v_lshlrev_b32 v4, 2, v4
    v_mov_b32 v5, 0
    s_lshl_b32 s52, s40, 8
    s_add_u32 s52, s52, 10821632
    buffer_load_dword v155, v4, s[32:35], s52 offen sc1
    buffer_load_dword v156, v4, s[32:35], s52 offen offset:128 sc1
    s_setprio 0
.p2align 6
K_loop:
    v_mfma_f32_32x32x16_bf16 v[40:55], v[112:115], v[16:19], 0
    s_add_u32 s48, s48, 16384
    v_exp_f32 v24, v24
    v_exp_f32 v25, v25
    v_exp_f32 v26, v26
    v_exp_f32 v27, v27
    v_cvt_pk_bf16_f32 v56, v24, v25
    v_cvt_pk_bf16_f32 v57, v26, v27
    v_mfma_f32_32x32x16_bf16 v[40:55], v[116:119], v[20:23], v[40:55]
    s_cmp_eq_u32 s48, 131072
    v_exp_f32 v28, v28
    v_exp_f32 v29, v29
    v_exp_f32 v30, v30
    v_exp_f32 v31, v31
    v_cvt_pk_bf16_f32 v58, v28, v29
    v_cvt_pk_bf16_f32 v59, v30, v31
    v_mfma_f32_32x32x16_bf16 v[88:103], v[136:139], v[64:67], v[88:103]
    s_cselect_b32 s48, 65536, s48
    v_exp_f32 v32, v32
    v_exp_f32 v33, v33
    v_exp_f32 v34, v34
    v_exp_f32 v35, v35
    v_cvt_pk_bf16_f32 v60, v32, v33
    v_cvt_pk_bf16_f32 v61, v34, v35
    v_mfma_f32_32x32x16_bf16 v[88:103], v[140:143], v[68:71], v[88:103]
    s_waitcnt lgkmcnt(2)
    v_exp_f32 v36, v36
    v_exp_f32 v37, v37
    v_exp_f32 v38, v38
    v_exp_f32 v39, v39
    v_cvt_pk_bf16_f32 v62, v36, v37
    v_smfmac_f32_16x16x64_bf16 v[108:111], v[144:147], v[64:71], v148
    ds_read_b128 v[112:115], v149 offset:8192
    ds_read_b128 v[116:119], v149 offset:9216
    v_cvt_pk_bf16_f32 v63, v38, v39
    v_mfma_f32_32x32x16_bf16 v[24:39], v[120:123], v[8:11], 0
    v_exp_f32 v40, v40
    v_exp_f32 v41, v41
    v_exp_f32 v42, v42
    v_exp_f32 v43, v43
    v_cvt_pk_bf16_f32 v64, v40, v41
    v_cvt_pk_bf16_f32 v65, v42, v43
    v_mfma_f32_32x32x16_bf16 v[24:39], v[124:127], v[12:15], v[24:39]
    s_waitcnt lgkmcnt(2)
    v_exp_f32 v44, v44
    v_exp_f32 v45, v45
    v_exp_f32 v46, v46
    v_exp_f32 v47, v47
    v_cvt_pk_bf16_f32 v66, v44, v45
    v_cvt_pk_bf16_f32 v67, v46, v47
    v_mfma_f32_32x32x16_bf16 v[72:87], v[128:131], v[56:59], v[72:87]
    ds_read_b32 v4, v154
    v_exp_f32 v48, v48
    v_exp_f32 v49, v49
    v_exp_f32 v50, v50
    v_exp_f32 v51, v51
    v_cvt_pk_bf16_f32 v68, v48, v49
    v_cvt_pk_bf16_f32 v69, v50, v51
    v_mfma_f32_32x32x16_bf16 v[72:87], v[132:135], v[60:63], v[72:87]
    v_exp_f32 v52, v52
    v_exp_f32 v53, v53
    v_exp_f32 v54, v54
    v_exp_f32 v55, v55
    v_cvt_pk_bf16_f32 v70, v52, v53
    v_smfmac_f32_16x16x64_bf16 v[104:107], v[144:147], v[56:63], v148
    ds_read_b128 v[136:139], v149 offset:6144
    ds_read_b128 v[140:143], v149 offset:7168
    v_cvt_pk_bf16_f32 v71, v54, v55
    v_mfma_f32_32x32x16_bf16 v[40:55], v[120:123], v[16:19], 0
    v_exp_f32 v24, v24
    v_exp_f32 v25, v25
    v_exp_f32 v26, v26
    v_exp_f32 v27, v27
    v_cvt_pk_bf16_f32 v56, v24, v25
    v_cvt_pk_bf16_f32 v57, v26, v27
    v_mfma_f32_32x32x16_bf16 v[40:55], v[124:127], v[20:23], v[40:55]
    v_exp_f32 v28, v28
    v_exp_f32 v29, v29
    v_exp_f32 v30, v30
    v_exp_f32 v31, v31
    v_cvt_pk_bf16_f32 v58, v28, v29
    v_cvt_pk_bf16_f32 v59, v30, v31
    v_mfma_f32_32x32x16_bf16 v[88:103], v[128:131], v[64:67], v[88:103]
    v_exp_f32 v32, v32
    v_exp_f32 v33, v33
    v_exp_f32 v34, v34
    v_exp_f32 v35, v35
    v_cvt_pk_bf16_f32 v60, v32, v33
    v_cvt_pk_bf16_f32 v61, v34, v35
    v_mfma_f32_32x32x16_bf16 v[88:103], v[132:135], v[68:71], v[88:103]
    s_waitcnt lgkmcnt(2)
    v_exp_f32 v36, v36
    v_exp_f32 v37, v37
    v_exp_f32 v38, v38
    v_exp_f32 v39, v39
    v_cvt_pk_bf16_f32 v62, v36, v37
    v_smfmac_f32_16x16x64_bf16 v[108:111], v[144:147], v[64:71], v148
    ds_read_b128 v[120:123], v149 offset:12288
    ds_read_b128 v[124:127], v149 offset:13312
    v_cvt_pk_bf16_f32 v63, v38, v39
    v_mfma_f32_32x32x16_bf16 v[24:39], v[112:115], v[8:11], 0
    v_readfirstlane_b32 s47, v4
    v_exp_f32 v40, v40
    v_exp_f32 v41, v41
    v_exp_f32 v42, v42
    v_exp_f32 v43, v43
    v_cvt_pk_bf16_f32 v64, v40, v41
    v_cvt_pk_bf16_f32 v65, v42, v43
    v_mfma_f32_32x32x16_bf16 v[24:39], v[116:119], v[12:15], v[24:39]
    s_waitcnt lgkmcnt(2)
    v_exp_f32 v44, v44
    v_exp_f32 v45, v45
    v_exp_f32 v46, v46
    v_exp_f32 v47, v47
    v_cvt_pk_bf16_f32 v66, v44, v45
    v_cvt_pk_bf16_f32 v67, v46, v47
    v_mfma_f32_32x32x16_bf16 v[72:87], v[136:139], v[56:59], v[72:87]
    s_cmp_ge_u32 s47, s49
    v_exp_f32 v48, v48
    v_exp_f32 v49, v49
    v_exp_f32 v50, v50
    v_exp_f32 v51, v51
    v_cvt_pk_bf16_f32 v68, v48, v49
    v_cvt_pk_bf16_f32 v69, v50, v51
    v_mfma_f32_32x32x16_bf16 v[72:87], v[140:143], v[60:63], v[72:87]
    s_cbranch_scc0 K_poll
K_ok:
    v_exp_f32 v52, v52
    v_exp_f32 v53, v53
    v_exp_f32 v54, v54
    v_exp_f32 v55, v55
    v_cvt_pk_bf16_f32 v70, v52, v53
    v_smfmac_f32_16x16x64_bf16 v[104:107], v[144:147], v[56:63], v148
    ds_read_b128 v[128:131], v149 offset:10240
    ds_read_b128 v[132:135], v149 offset:11264
    v_cvt_pk_bf16_f32 v71, v54, v55
    v_mfma_f32_32x32x16_bf16 v[40:55], v[112:115], v[16:19], 0
    v_exp_f32 v24, v24
    v_exp_f32 v25, v25
    v_exp_f32 v26, v26
    v_exp_f32 v27, v27
    v_cvt_pk_bf16_f32 v56, v24, v25
    v_cvt_pk_bf16_f32 v57, v26, v27
    v_mfma_f32_32x32x16_bf16 v[40:55], v[116:119], v[20:23], v[40:55]
    v_exp_f32 v28, v28
    v_exp_f32 v29, v29
    v_exp_f32 v30, v30
    v_exp_f32 v31, v31
    v_cvt_pk_bf16_f32 v58, v28, v29
    v_cvt_pk_bf16_f32 v59, v30, v31
    v_mfma_f32_32x32x16_bf16 v[88:103], v[136:139], v[64:67], v[88:103]
    v_exp_f32 v32, v32
    v_exp_f32 v33, v33
    v_exp_f32 v34, v34
    v_exp_f32 v35, v35
    v_cvt_pk_bf16_f32 v60, v32, v33
    v_cvt_pk_bf16_f32 v61, v34, v35
    v_mfma_f32_32x32x16_bf16 v[88:103], v[140:143], v[68:71], v[88:103]
    s_waitcnt lgkmcnt(2)
    v_exp_f32 v36, v36
    v_exp_f32 v37, v37
    v_exp_f32 v38, v38
    v_exp_f32 v39, v39
    v_cvt_pk_bf16_f32 v62, v36, v37
    v_smfmac_f32_16x16x64_bf16 v[108:111], v[144:147], v[64:71], v148
    ds_read_b128 v[112:115], v150 offset:0
    ds_read_b128 v[116:119], v150 offset:1024
    v_cvt_pk_bf16_f32 v63, v38, v39
    v_mfma_f32_32x32x16_bf16 v[24:39], v[120:123], v[8:11], 0
    s_add_u32 s49, s49, 1
    v_exp_f32 v40, v40
    v_exp_f32 v41, v41
    v_exp_f32 v42, v42
    v_exp_f32 v43, v43
    v_cvt_pk_bf16_f32 v64, v40, v41
    v_cvt_pk_bf16_f32 v65, v42, v43
    v_mfma_f32_32x32x16_bf16 v[24:39], v[124:127], v[12:15], v[24:39]
    s_waitcnt lgkmcnt(2)
    v_exp_f32 v44, v44
    v_exp_f32 v45, v45
    v_exp_f32 v46, v46
    v_exp_f32 v47, v47
    v_cvt_pk_bf16_f32 v66, v44, v45
    v_cvt_pk_bf16_f32 v67, v46, v47
    v_mfma_f32_32x32x16_bf16 v[72:87], v[128:131], v[56:59], v[72:87]
    v_exp_f32 v48, v48
    v_exp_f32 v49, v49
    v_exp_f32 v50, v50
    v_exp_f32 v51, v51
    v_cvt_pk_bf16_f32 v68, v48, v49
    v_cvt_pk_bf16_f32 v69, v50, v51
    v_mfma_f32_32x32x16_bf16 v[72:87], v[132:135], v[60:63], v[72:87]
    v_exp_f32 v52, v52
    v_exp_f32 v53, v53
    v_exp_f32 v54, v54
    v_exp_f32 v55, v55
    v_cvt_pk_bf16_f32 v70, v52, v53
    v_smfmac_f32_16x16x64_bf16 v[104:107], v[144:147], v[56:63], v148
    ds_read_b128 v[136:139], v149 offset:14336
    ds_read_b128 v[140:143], v149 offset:15360
    v_cvt_pk_bf16_f32 v71, v54, v55
    v_mfma_f32_32x32x16_bf16 v[40:55], v[120:123], v[16:19], 0
    v_exp_f32 v24, v24
    v_exp_f32 v25, v25
    v_exp_f32 v26, v26
    v_exp_f32 v27, v27
    v_cvt_pk_bf16_f32 v56, v24, v25
    v_cvt_pk_bf16_f32 v57, v26, v27
    v_mfma_f32_32x32x16_bf16 v[40:55], v[124:127], v[20:23], v[40:55]
    v_exp_f32 v28, v28
    v_exp_f32 v29, v29
    v_exp_f32 v30, v30
    v_exp_f32 v31, v31
    v_cvt_pk_bf16_f32 v58, v28, v29
    v_cvt_pk_bf16_f32 v59, v30, v31
    v_mfma_f32_32x32x16_bf16 v[88:103], v[128:131], v[64:67], v[88:103]
    v_exp_f32 v32, v32
    v_exp_f32 v33, v33
    v_exp_f32 v34, v34
    v_exp_f32 v35, v35
    v_cvt_pk_bf16_f32 v60, v32, v33
    v_cvt_pk_bf16_f32 v61, v34, v35
    v_mfma_f32_32x32x16_bf16 v[88:103], v[132:135], v[68:71], v[88:103]
    s_waitcnt lgkmcnt(2)
    v_exp_f32 v36, v36
    v_exp_f32 v37, v37
    v_exp_f32 v38, v38
    v_exp_f32 v39, v39
    v_cvt_pk_bf16_f32 v62, v36, v37
    v_smfmac_f32_16x16x64_bf16 v[108:111], v[144:147], v[64:71], v148
    ds_read_b128 v[120:123], v150 offset:4096
    ds_read_b128 v[124:127], v150 offset:5120
    v_cvt_pk_bf16_f32 v63, v38, v39
    v_mfma_f32_32x32x16_bf16 v[24:39], v[112:115], v[8:11], 0
    v_mov_b32 v149, v150
    v_add_u32 v150, s48, v3
    v_exp_f32 v40, v40
    v_exp_f32 v41, v41
    v_exp_f32 v42, v42
    v_exp_f32 v43, v43
    v_cvt_pk_bf16_f32 v64, v40, v41
    v_cvt_pk_bf16_f32 v65, v42, v43
    v_mfma_f32_32x32x16_bf16 v[24:39], v[116:119], v[12:15], v[24:39]
    s_waitcnt lgkmcnt(2)
    v_exp_f32 v44, v44
    v_exp_f32 v45, v45
    v_exp_f32 v46, v46
    v_exp_f32 v47, v47
    v_cvt_pk_bf16_f32 v66, v44, v45
    v_cvt_pk_bf16_f32 v67, v46, v47
    v_mfma_f32_32x32x16_bf16 v[72:87], v[136:139], v[56:59], v[72:87]
    ds_write_b32 v151, v152
    v_exp_f32 v48, v48
    v_exp_f32 v49, v49
    v_exp_f32 v50, v50
    v_exp_f32 v51, v51
    v_cvt_pk_bf16_f32 v68, v48, v49
    v_cvt_pk_bf16_f32 v69, v50, v51
    v_mfma_f32_32x32x16_bf16 v[72:87], v[140:143], v[60:63], v[72:87]
    s_cmp_lt_u32 s49, 18
    v_add_u32 v152, 1, v152
    v_exp_f32 v52, v52
    v_exp_f32 v53, v53
    v_exp_f32 v54, v54
    v_exp_f32 v55, v55
    v_cvt_pk_bf16_f32 v70, v52, v53
    v_smfmac_f32_16x16x64_bf16 v[104:107], v[144:147], v[56:63], v148
    ds_read_b128 v[128:131], v149 offset:2048
    ds_read_b128 v[132:135], v149 offset:3072
    v_cvt_pk_bf16_f32 v71, v54, v55
    s_cbranch_scc1 K_loop
    s_setprio 3
    s_waitcnt lgkmcnt(0)
    v_mfma_f32_32x32x16_bf16 v[88:103], v[136:139], v[64:67], v[88:103]
    v_mfma_f32_32x32x16_bf16 v[88:103], v[140:143], v[68:71], v[88:103]
    v_smfmac_f32_16x16x64_bf16 v[108:111], v[144:147], v[64:71], v148
    s_mov_b32 s50, 0x5f800000
    s_mov_b32 s51, 0x1f800000
    s_add_u32 s45, s45, 4194304
    s_add_u32 s46, s46, 4194304
    s_nop 3
    v_add_f32 v104, v104, v105
    v_maximum3_f32 v4, abs(v72), abs(v73), 0
    v_maximum3_f32 v4, abs(v74), abs(v75), v4
    v_maximum3_f32 v4, abs(v76), abs(v77), v4
    v_maximum3_f32 v4, abs(v78), abs(v79), v4
    v_maximum3_f32 v4, abs(v80), abs(v81), v4
    v_maximum3_f32 v4, abs(v82), abs(v83), v4
    v_maximum3_f32 v4, abs(v84), abs(v85), v4
    v_maximum3_f32 v4, abs(v86), abs(v87), v4
    v_mul_f32 v4, s51, v4
    v_maximum3_f32 v4, v4, v104, v104
    v_cmp_nle_f32 vcc, v4, s50
    v_cmp_nge_f32 s[52:53], v104, s51
    s_nop 0
    s_or_b64 vcc, vcc, s[52:53]
    s_cbranch_vccnz K_fallback
    v_rcp_f32 v6, v104
    s_nop 0
    v_pk_mul_f32 v[72:73], v[72:73], v[6:7] op_sel_hi:[1,0]
    v_pk_mul_f32 v[74:75], v[74:75], v[6:7] op_sel_hi:[1,0]
    v_pk_mul_f32 v[76:77], v[76:77], v[6:7] op_sel_hi:[1,0]
    v_pk_mul_f32 v[78:79], v[78:79], v[6:7] op_sel_hi:[1,0]
    v_pk_mul_f32 v[80:81], v[80:81], v[6:7] op_sel_hi:[1,0]
    v_pk_mul_f32 v[82:83], v[82:83], v[6:7] op_sel_hi:[1,0]
    v_pk_mul_f32 v[84:85], v[84:85], v[6:7] op_sel_hi:[1,0]
    v_pk_mul_f32 v[86:87], v[86:87], v[6:7] op_sel_hi:[1,0]
    v_cvt_pk_bf16_f32 v56, v72, v73
    v_cvt_pk_bf16_f32 v57, v74, v75
    v_cvt_pk_bf16_f32 v58, v76, v77
    v_cvt_pk_bf16_f32 v59, v78, v79
    v_cvt_pk_bf16_f32 v60, v80, v81
    v_cvt_pk_bf16_f32 v61, v82, v83
    v_cvt_pk_bf16_f32 v62, v84, v85
    v_cvt_pk_bf16_f32 v63, v86, v87
    buffer_store_dwordx4 v[56:59], v3, s[32:35], s45 offen sc1
    buffer_store_dwordx4 v[60:63], v3, s[32:35], s45 offen offset:1024 sc1
    v_add_f32 v108, v108, v109
    v_maximum3_f32 v4, abs(v88), abs(v89), 0
    v_maximum3_f32 v4, abs(v90), abs(v91), v4
    v_maximum3_f32 v4, abs(v92), abs(v93), v4
    v_maximum3_f32 v4, abs(v94), abs(v95), v4
    v_maximum3_f32 v4, abs(v96), abs(v97), v4
    v_maximum3_f32 v4, abs(v98), abs(v99), v4
    v_maximum3_f32 v4, abs(v100), abs(v101), v4
    v_maximum3_f32 v4, abs(v102), abs(v103), v4
    v_mul_f32 v4, s51, v4
    v_maximum3_f32 v4, v4, v108, v108
    v_cmp_nle_f32 vcc, v4, s50
    v_cmp_nge_f32 s[52:53], v108, s51
    s_nop 0
    s_or_b64 vcc, vcc, s[52:53]
    s_cbranch_vccnz K_fallback
K_normB:
    v_rcp_f32 v6, v108
    s_nop 0
    v_pk_mul_f32 v[88:89], v[88:89], v[6:7] op_sel_hi:[1,0]
    v_pk_mul_f32 v[90:91], v[90:91], v[6:7] op_sel_hi:[1,0]
    v_pk_mul_f32 v[92:93], v[92:93], v[6:7] op_sel_hi:[1,0]
    v_pk_mul_f32 v[94:95], v[94:95], v[6:7] op_sel_hi:[1,0]
    v_pk_mul_f32 v[96:97], v[96:97], v[6:7] op_sel_hi:[1,0]
    v_pk_mul_f32 v[98:99], v[98:99], v[6:7] op_sel_hi:[1,0]
    v_pk_mul_f32 v[100:101], v[100:101], v[6:7] op_sel_hi:[1,0]
    v_pk_mul_f32 v[102:103], v[102:103], v[6:7] op_sel_hi:[1,0]
    v_cvt_pk_bf16_f32 v64, v88, v89
    v_cvt_pk_bf16_f32 v65, v90, v91
    v_cvt_pk_bf16_f32 v66, v92, v93
    v_cvt_pk_bf16_f32 v67, v94, v95
    v_cvt_pk_bf16_f32 v68, v96, v97
    v_cvt_pk_bf16_f32 v69, v98, v99
    v_cvt_pk_bf16_f32 v70, v100, v101
    v_cvt_pk_bf16_f32 v71, v102, v103
    buffer_store_dwordx4 v[64:67], v3, s[32:35], s46 offen sc1
    buffer_store_dwordx4 v[68:71], v3, s[32:35], s46 offen offset:1024 sc1
    v_lshrrev_b32 v6, 4, v1
    v_and_b32 v6, 1, v6
    v_lshrrev_b32 v7, 5, v1
    v_bfe_u32 v8, v1, 2, 2
    v_and_b32 v9, 3, v1
    s_lshl_b32 s55, s41, 2
    s_add_u32 s55, s55, s60
    v_lshl_add_u32 v20, v7, 2, v8
    v_lshlrev_b32 v22, 1, v6
    v_lshrrev_b32 v23, 1, v9
    s_lshl_b32 s53, s60, 2
    v_add3_u32 v22, v22, v23, s53
    v_lshlrev_b32 v23, 2, v8
    v_xor_b32 v22, v22, v23
    v_lshlrev_b32 v22, 4, v22
    v_lshl_add_u32 v22, v20, 8, v22
    v_and_b32 v23, 1, v9
    v_lshl_add_u32 v9, v23, 3, v22
    v_mov_b32 v4, 0
    v_and_b32 v10, 31, v1
    s_lshl_b32 s56, s40, 6
    v_add_u32 v11, s56, v10
    s_lshl_b32 s72, s55, 6
    s_add_u32 s73, s72, 0x10000
    v_lshlrev_b32 v6, 11, v11
    v_lshl_add_u32 v6, v7, 4, v6
    v_add_u32 v16, s53, v7
    v_and_b32 v17, 15, v10
    v_xor_b32 v16, v16, v17
    v_lshlrev_b32 v16, 4, v16
    v_lshl_add_u32 v16, v10, 8, v16
    v_add_u32 v16, 131072, v16
    v_xor_b32 v17, 32, v16
    v_add_u32 v12, 65536, v3
    s_lshr_b32 s56, s60, 1
    s_lshl_b32 s56, s56, 13
    s_and_b32 s57, s60, 1
    s_lshl_b32 s57, s57, 11
    s_add_u32 s56, s56, s57
    v_add_u32 v18, s56, v12
    v_mov_b32 v13, v9
    s_mov_b32 s44, 65536
    s_mov_b32 s43, 0
    s_mov_b32 s49, 0
    s_mov_b32 s36, s26
    s_mov_b32 s37, s27
    s_mov_b32 s38, 0x400000
    s_mov_b32 s39, 0x00020000
    s_barrier
    ds_write_b128 v18, v[56:59]
    ds_write_b128 v18, v[60:63] offset:1024
    ds_write_b128 v18, v[64:67] offset:4096
    ds_write_b128 v18, v[68:71] offset:5120
    ds_read_b128 v[136:139], v16
    ds_read_b128 v[140:143], v17
    ds_read_b128 v[144:147], v16 offset:8192
    ds_read_b128 v[148:151], v17 offset:8192
    s_waitcnt vmcnt(0) lgkmcnt(0)
    s_barrier
    s_waitcnt lgkmcnt(8)
    s_add_u32 s44, s44, 0x2000
    s_cmp_eq_u32 s44, 98304
    ds_read_b128 v[160:163], v12 offset:0
    ds_read_b64_tr_b16 v[192:193], v13 offset:0
    ds_read_b64_tr_b16 v[194:195], v13 offset:2048
    s_cselect_b32 s44, 131072, s44
    s_cmp_eq_u32 s44, 147456
    ds_read_b128 v[176:179], v12 offset:4096
    ds_read_b128 v[164:167], v12 offset:1024
    s_waitcnt lgkmcnt(5)
    s_cselect_b32 s44, 65536, s44
    s_add_u32 s43, s43, 0x4000
    ds_read_b64_tr_b16 v[196:197], v13 offset:4096
    ds_read_b64_tr_b16 v[198:199], v13 offset:6144
    ds_read_b128 v[180:183], v12 offset:5120
    s_cmp_eq_u32 s43, 0x10000
    s_cselect_b32 s43, 0x18000, s43
    ds_read_b128 v[168:171], v12 offset:2048
    ds_read_b64_tr_b16 v[200:201], v13 offset:8192
    ds_read_b64_tr_b16 v[202:203], v13 offset:10240
    s_cmp_eq_u32 s43, 0x20000
    s_cselect_b32 s43, 0, s43
    ds_read_b128 v[184:187], v12 offset:6144
    ds_read_b128 v[172:175], v12 offset:3072
    s_waitcnt lgkmcnt(8)
    ds_read_b64_tr_b16 v[204:205], v13 offset:12288
    ds_read_b64_tr_b16 v[206:207], v13 offset:14336
    ds_read_b128 v[188:191], v12 offset:7168
    v_add_u32 v12, s44, v3
    v_add_u32 v13, s43, v9
    s_add_u32 s49, s49, 1
    s_waitcnt lgkmcnt(8)
    v_mfma_f32_32x32x16_bf16 v[72:87], v[192:195], v[160:163], 0
    s_add_u32 s44, s44, 0x2000
    s_cmp_eq_u32 s44, 98304
    ds_read_b128 v[208:211], v12 offset:0
    ds_read_b64_tr_b16 v[240:241], v13 offset:0
    ds_read_b64_tr_b16 v[242:243], v13 offset:2048
    v_mfma_f32_32x32x16_bf16 v[88:103], v[192:195], v[176:179], 0
    s_cselect_b32 s44, 131072, s44
    s_cmp_eq_u32 s44, 147456
    ds_read_b128 v[224:227], v12 offset:4096
    ds_read_b128 v[212:215], v12 offset:1024
    s_waitcnt lgkmcnt(5)
    v_mfma_f32_32x32x16_bf16 v[72:87], v[196:199], v[164:167], v[72:87]
    s_cselect_b32 s44, 65536, s44
    s_add_u32 s43, s43, 0x4000
    ds_read_b64_tr_b16 v[244:245], v13 offset:4096
    ds_read_b64_tr_b16 v[246:247], v13 offset:6144
    ds_read_b128 v[228:231], v12 offset:5120
    v_mfma_f32_32x32x16_bf16 v[88:103], v[196:199], v[180:183], v[88:103]
    s_cmp_eq_u32 s43, 0x10000
    s_cselect_b32 s43, 0x18000, s43
    ds_read_b128 v[216:219], v12 offset:2048
    ds_read_b64_tr_b16 v[248:249], v13 offset:8192
    ds_read_b64_tr_b16 v[250:251], v13 offset:10240
    v_mfma_f32_32x32x16_bf16 v[72:87], v[200:203], v[168:171], v[72:87]
    s_cmp_eq_u32 s43, 0x20000
    s_cselect_b32 s43, 0, s43
    ds_read_b128 v[232:235], v12 offset:6144
    ds_read_b128 v[220:223], v12 offset:3072
    s_waitcnt lgkmcnt(8)
    v_mfma_f32_32x32x16_bf16 v[88:103], v[200:203], v[184:187], v[88:103]
    ds_read_b64_tr_b16 v[252:253], v13 offset:12288
    ds_read_b64_tr_b16 v[254:255], v13 offset:14336
    ds_read_b128 v[236:239], v12 offset:7168
    v_mfma_f32_32x32x16_bf16 v[72:87], v[204:207], v[172:175], v[72:87]
    v_add_u32 v12, s44, v3
    v_add_u32 v13, s43, v9
    s_add_u32 s49, s49, 1
    v_mfma_f32_32x32x16_bf16 v[88:103], v[204:207], v[188:191], v[88:103]
    s_waitcnt lgkmcnt(0)
    s_barrier
    v_sub_f32 v14, 1.0, v155
    v_sub_f32 v15, 1.0, v156
    v_lshlrev_b32 v104, 16, v136
    v_and_b32 v105, 0xffff0000, v136
    v_lshlrev_b32 v106, 16, v137
    v_and_b32 v107, 0xffff0000, v137
    v_lshlrev_b32 v108, 16, v138
    v_and_b32 v109, 0xffff0000, v138
    v_lshlrev_b32 v110, 16, v139
    v_and_b32 v111, 0xffff0000, v139
    v_lshlrev_b32 v112, 16, v140
    v_and_b32 v113, 0xffff0000, v140
    v_lshlrev_b32 v114, 16, v141
    v_and_b32 v115, 0xffff0000, v141
    v_lshlrev_b32 v116, 16, v142
    v_and_b32 v117, 0xffff0000, v142
    v_lshlrev_b32 v118, 16, v143
    v_and_b32 v119, 0xffff0000, v143
    v_lshlrev_b32 v120, 16, v144
    v_and_b32 v121, 0xffff0000, v144
    v_lshlrev_b32 v122, 16, v145
    v_and_b32 v123, 0xffff0000, v145
    v_lshlrev_b32 v124, 16, v146
    v_and_b32 v125, 0xffff0000, v146
    v_lshlrev_b32 v126, 16, v147
    v_and_b32 v127, 0xffff0000, v147
    v_lshlrev_b32 v128, 16, v148
    v_and_b32 v129, 0xffff0000, v148
    v_lshlrev_b32 v130, 16, v149
    v_and_b32 v131, 0xffff0000, v149
    v_lshlrev_b32 v132, 16, v150
    v_and_b32 v133, 0xffff0000, v150
    v_lshlrev_b32 v134, 16, v151
    v_and_b32 v135, 0xffff0000, v151
    v_pk_mul_f32 v[104:105], v[104:105], v[14:15] op_sel:[0,0] op_sel_hi:[1,0]
    v_pk_mul_f32 v[106:107], v[106:107], v[14:15] op_sel:[0,0] op_sel_hi:[1,0]
    v_pk_mul_f32 v[108:109], v[108:109], v[14:15] op_sel:[0,0] op_sel_hi:[1,0]
    v_pk_mul_f32 v[110:111], v[110:111], v[14:15] op_sel:[0,0] op_sel_hi:[1,0]
    v_pk_mul_f32 v[112:113], v[112:113], v[14:15] op_sel:[0,0] op_sel_hi:[1,0]
    v_pk_mul_f32 v[114:115], v[114:115], v[14:15] op_sel:[0,0] op_sel_hi:[1,0]
    v_pk_mul_f32 v[116:117], v[116:117], v[14:15] op_sel:[0,0] op_sel_hi:[1,0]
    v_pk_mul_f32 v[118:119], v[118:119], v[14:15] op_sel:[0,0] op_sel_hi:[1,0]
    v_pk_mul_f32 v[120:121], v[120:121], v[14:15] op_sel:[0,1] op_sel_hi:[1,1]
    v_pk_mul_f32 v[122:123], v[122:123], v[14:15] op_sel:[0,1] op_sel_hi:[1,1]
    v_pk_mul_f32 v[124:125], v[124:125], v[14:15] op_sel:[0,1] op_sel_hi:[1,1]
    v_pk_mul_f32 v[126:127], v[126:127], v[14:15] op_sel:[0,1] op_sel_hi:[1,1]
    v_pk_mul_f32 v[128:129], v[128:129], v[14:15] op_sel:[0,1] op_sel_hi:[1,1]
    v_pk_mul_f32 v[130:131], v[130:131], v[14:15] op_sel:[0,1] op_sel_hi:[1,1]
    v_pk_mul_f32 v[132:133], v[132:133], v[14:15] op_sel:[0,1] op_sel_hi:[1,1]
    v_pk_mul_f32 v[134:135], v[134:135], v[14:15] op_sel:[0,1] op_sel_hi:[1,1]
    s_barrier
.p2align 6
P3_loop:
    s_barrier
    s_waitcnt lgkmcnt(8)
    v_mfma_f32_32x32x16_bf16 v[72:87], v[240:243], v[208:211], v[72:87]
    s_add_u32 s44, s44, 0x2000
    s_cmp_eq_u32 s44, 98304
    ds_read_b128 v[160:163], v12 offset:0
    ds_read_b64_tr_b16 v[192:193], v13 offset:0
    ds_read_b64_tr_b16 v[194:195], v13 offset:2048
    v_mfma_f32_32x32x16_bf16 v[88:103], v[240:243], v[224:227], v[88:103]
    s_cselect_b32 s44, 131072, s44
    s_cmp_eq_u32 s44, 147456
    ds_read_b128 v[176:179], v12 offset:4096
    ds_read_b128 v[164:167], v12 offset:1024
    s_waitcnt lgkmcnt(5)
    v_mfma_f32_32x32x16_bf16 v[72:87], v[244:247], v[212:215], v[72:87]
    s_cselect_b32 s44, 65536, s44
    s_add_u32 s43, s43, 0x4000
    ds_read_b64_tr_b16 v[196:197], v13 offset:4096
    ds_read_b64_tr_b16 v[198:199], v13 offset:6144
    ds_read_b128 v[180:183], v12 offset:5120
    v_mfma_f32_32x32x16_bf16 v[88:103], v[244:247], v[228:231], v[88:103]
    s_cmp_eq_u32 s43, 0x10000
    s_cselect_b32 s43, 0x18000, s43
    ds_read_b128 v[168:171], v12 offset:2048
    ds_read_b64_tr_b16 v[200:201], v13 offset:8192
    ds_read_b64_tr_b16 v[202:203], v13 offset:10240
    v_mfma_f32_32x32x16_bf16 v[72:87], v[248:251], v[216:219], v[72:87]
    s_cmp_eq_u32 s43, 0x20000
    s_cselect_b32 s43, 0, s43
    ds_read_b128 v[184:187], v12 offset:6144
    ds_read_b128 v[172:175], v12 offset:3072
    s_waitcnt lgkmcnt(8)
    v_mfma_f32_32x32x16_bf16 v[88:103], v[248:251], v[232:235], v[88:103]
    ds_read_b64_tr_b16 v[204:205], v13 offset:12288
    ds_read_b64_tr_b16 v[206:207], v13 offset:14336
    ds_read_b128 v[188:191], v12 offset:7168
    v_mfma_f32_32x32x16_bf16 v[72:87], v[252:255], v[220:223], v[72:87]
    v_add_u32 v12, s44, v3
    v_add_u32 v13, s43, v9
    s_add_u32 s49, s49, 1
    v_mfma_f32_32x32x16_bf16 v[88:103], v[252:255], v[236:239], v[88:103]
    s_barrier
    s_waitcnt lgkmcnt(8)
    v_mfma_f32_32x32x16_bf16 v[72:87], v[192:195], v[160:163], v[72:87]
    s_add_u32 s44, s44, 0x2000
    s_cmp_eq_u32 s44, 98304
    ds_read_b128 v[208:211], v12 offset:0
    ds_read_b64_tr_b16 v[240:241], v13 offset:0
    ds_read_b64_tr_b16 v[242:243], v13 offset:2048
    v_mfma_f32_32x32x16_bf16 v[88:103], v[192:195], v[176:179], v[88:103]
    s_cselect_b32 s44, 131072, s44
    s_cmp_eq_u32 s44, 147456
    ds_read_b128 v[224:227], v12 offset:4096
    ds_read_b128 v[212:215], v12 offset:1024
    s_waitcnt lgkmcnt(5)
    v_mfma_f32_32x32x16_bf16 v[72:87], v[196:199], v[164:167], v[72:87]
    s_cselect_b32 s44, 65536, s44
    s_add_u32 s43, s43, 0x4000
    ds_read_b64_tr_b16 v[244:245], v13 offset:4096
    ds_read_b64_tr_b16 v[246:247], v13 offset:6144
    ds_read_b128 v[228:231], v12 offset:5120
    v_mfma_f32_32x32x16_bf16 v[88:103], v[196:199], v[180:183], v[88:103]
    s_cmp_eq_u32 s43, 0x10000
    s_cselect_b32 s43, 0x18000, s43
    ds_read_b128 v[216:219], v12 offset:2048
    ds_read_b64_tr_b16 v[248:249], v13 offset:8192
    ds_read_b64_tr_b16 v[250:251], v13 offset:10240
    v_mfma_f32_32x32x16_bf16 v[72:87], v[200:203], v[168:171], v[72:87]
    s_cmp_eq_u32 s43, 0x20000
    s_cselect_b32 s43, 0, s43
    ds_read_b128 v[232:235], v12 offset:6144
    ds_read_b128 v[220:223], v12 offset:3072
    s_waitcnt lgkmcnt(8)
    v_mfma_f32_32x32x16_bf16 v[88:103], v[200:203], v[184:187], v[88:103]
    ds_read_b64_tr_b16 v[252:253], v13 offset:12288
    ds_read_b64_tr_b16 v[254:255], v13 offset:14336
    ds_read_b128 v[236:239], v12 offset:7168
    v_mfma_f32_32x32x16_bf16 v[72:87], v[204:207], v[172:175], v[72:87]
    v_add_u32 v12, s44, v3
    v_add_u32 v13, s43, v9
    s_add_u32 s49, s49, 1
    s_cmp_lt_u32 s49, 16
    v_mfma_f32_32x32x16_bf16 v[88:103], v[204:207], v[188:191], v[88:103]
    s_cbranch_scc1 P3_loop
    s_waitcnt lgkmcnt(0)
    v_mfma_f32_32x32x16_bf16 v[72:87], v[240:243], v[208:211], v[72:87]
    v_mfma_f32_32x32x16_bf16 v[72:87], v[244:247], v[212:215], v[72:87]
    v_mfma_f32_32x32x16_bf16 v[72:87], v[248:251], v[216:219], v[72:87]
    v_mfma_f32_32x32x16_bf16 v[72:87], v[252:255], v[220:223], v[72:87]
    v_mfma_f32_32x32x16_bf16 v[88:103], v[240:243], v[224:227], v[88:103]
    v_mfma_f32_32x32x16_bf16 v[88:103], v[244:247], v[228:231], v[88:103]
    v_mfma_f32_32x32x16_bf16 v[88:103], v[248:251], v[232:235], v[88:103]
    v_mfma_f32_32x32x16_bf16 v[88:103], v[252:255], v[236:239], v[88:103]
    s_nop 7
    v_permlane32_swap_b32 v72, v76
    v_permlane32_swap_b32 v73, v77
    v_permlane32_swap_b32 v74, v78
    v_permlane32_swap_b32 v75, v79
    v_permlane32_swap_b32 v80, v84
    v_permlane32_swap_b32 v81, v85
    v_permlane32_swap_b32 v82, v86
    v_permlane32_swap_b32 v83, v87
    v_fmac_f32 v104, v72, v155
    v_fmac_f32 v105, v73, v155
    v_fmac_f32 v106, v74, v155
    v_fmac_f32 v107, v75, v155
    v_fmac_f32 v108, v76, v155
    v_fmac_f32 v109, v77, v155
    v_fmac_f32 v110, v78, v155
    v_fmac_f32 v111, v79, v155
    v_fmac_f32 v112, v80, v155
    v_fmac_f32 v113, v81, v155
    v_fmac_f32 v114, v82, v155
    v_fmac_f32 v115, v83, v155
    v_fmac_f32 v116, v84, v155
    v_fmac_f32 v117, v85, v155
    v_fmac_f32 v118, v86, v155
    v_fmac_f32 v119, v87, v155
    v_cvt_pk_bf16_f32 v24, v104, v105
    v_cvt_pk_bf16_f32 v25, v106, v107
    v_cvt_pk_bf16_f32 v26, v108, v109
    v_cvt_pk_bf16_f32 v27, v110, v111
    v_cvt_pk_bf16_f32 v28, v112, v113
    v_cvt_pk_bf16_f32 v29, v114, v115
    v_cvt_pk_bf16_f32 v30, v116, v117
    v_cvt_pk_bf16_f32 v31, v118, v119
    buffer_store_dwordx4 v[24:27], v6, s[36:39], s72 offen
    buffer_store_dwordx4 v[28:31], v6, s[36:39], s72 offen offset:32
    v_permlane32_swap_b32 v88, v92
    v_permlane32_swap_b32 v89, v93
    v_permlane32_swap_b32 v90, v94
    v_permlane32_swap_b32 v91, v95
    v_permlane32_swap_b32 v96, v100
    v_permlane32_swap_b32 v97, v101
    v_permlane32_swap_b32 v98, v102
    v_permlane32_swap_b32 v99, v103
    v_fmac_f32 v120, v88, v156
    v_fmac_f32 v121, v89, v156
    v_fmac_f32 v122, v90, v156
    v_fmac_f32 v123, v91, v156
    v_fmac_f32 v124, v92, v156
    v_fmac_f32 v125, v93, v156
    v_fmac_f32 v126, v94, v156
    v_fmac_f32 v127, v95, v156
    v_fmac_f32 v128, v96, v156
    v_fmac_f32 v129, v97, v156
    v_fmac_f32 v130, v98, v156
    v_fmac_f32 v131, v99, v156
    v_fmac_f32 v132, v100, v156
    v_fmac_f32 v133, v101, v156
    v_fmac_f32 v134, v102, v156
    v_fmac_f32 v135, v103, v156
    v_cvt_pk_bf16_f32 v32, v120, v121
    v_cvt_pk_bf16_f32 v33, v122, v123
    v_cvt_pk_bf16_f32 v34, v124, v125
    v_cvt_pk_bf16_f32 v35, v126, v127
    v_cvt_pk_bf16_f32 v36, v128, v129
    v_cvt_pk_bf16_f32 v37, v130, v131
    v_cvt_pk_bf16_f32 v38, v132, v133
    v_cvt_pk_bf16_f32 v39, v134, v135
    buffer_store_dwordx4 v[32:35], v6, s[36:39], s73 offen
    buffer_store_dwordx4 v[36:39], v6, s[36:39], s73 offen offset:32
K_fin:
K_end:
    s_endpgm
K_poll:
    s_cmp_gt_u32 s49, 16
    s_cbranch_scc1 K_ok
    ds_read_b32 v4, v154
    s_waitcnt lgkmcnt(0)
    v_readfirstlane_b32 s47, v4
    s_nop 0
    s_cmp_ge_u32 s47, s49
    s_cbranch_scc1 K_ok
    s_branch K_poll
K_A0:
    s_setprio 0
    v_mov_b32 v15, 152716
K_wS1:
    s_sleep 2
    ds_read_b32 v14, v15
    s_waitcnt lgkmcnt(0)
    v_readfirstlane_b32 s57, v14
    s_nop 0
    s_cmp_eq_u32 s57, 0
    s_cbranch_scc1 K_wS1
    s_mov_b32 s50, 10813440
    s_mov_b32 s51, 10817536
    buffer_load_dwordx4 v[16:19], v3, s[32:35], s50 offen offset:0 sc1
    buffer_load_dwordx4 v[20:23], v3, s[32:35], s50 offen offset:1024 sc1
    buffer_load_dwordx4 v[24:27], v3, s[32:35], s50 offen offset:2048 sc1
    buffer_load_dwordx4 v[28:31], v3, s[32:35], s50 offen offset:3072 sc1
    buffer_load_dwordx4 v[32:35], v3, s[32:35], s51 offen offset:0 sc1
    buffer_load_dwordx4 v[36:39], v3, s[32:35], s51 offen offset:1024 sc1
    buffer_load_dwordx4 v[40:43], v3, s[32:35], s51 offen offset:2048 sc1
    buffer_load_dwordx4 v[44:47], v3, s[32:35], s51 offen offset:3072 sc1
    s_mov_b32 s64, s18
    s_mov_b32 s65, s19
    s_mov_b32 s66, 0x700000
    s_mov_b32 s67, 0x00020000
    s_mov_b32 s68, s20
    s_mov_b32 s69, s21
    s_mov_b32 s70, 0x700000
    s_mov_b32 s71, 0x00020000
    s_and_b32 s74, s62, 3
    v_lshrrev_b32 v4, 3, v1
    v_mul_u32_u24 v4, 7168, v4
    v_and_b32 v5, 7, v1
    v_lshl_add_u32 v4, v5, 4, v4
    s_lshr_b32 s47, s62, 2
    s_lshl_b32 s47, s47, 7
    s_mul_i32 s48, s74, 1835008
    s_add_u32 s47, s47, s48
    s_mov_b32 s48, 0
    s_lshl_b32 s75, s74, 9
    v_mov_b32 v10, 0
    s_mov_b32 s49, 0
    s_mov_b32 s52, 147456
    s_waitcnt vmcnt(0)
K2_top:
    s_cmp_eq_u32 s61, 0
    s_cbranch_scc1 K2_top_nodma
    s_waitcnt vmcnt(14)
    s_add_u32 m0, s48, 0
    s_nop 0
    buffer_load_dwordx4 v4, s[64:67], s47 offen lds
    s_add_u32 m0, s48, 32768
    s_add_u32 s48, s48, 1024
    buffer_load_dwordx4 v4, s[68:71], s47 offen lds
    s_add_u32 s47, s47, 57344
    s_add_u32 m0, s48, 0
    s_nop 0
    buffer_load_dwordx4 v4, s[64:67], s47 offen lds
    s_add_u32 m0, s48, 32768
    s_add_u32 s48, s48, 1024
    buffer_load_dwordx4 v4, s[68:71], s47 offen lds
    s_add_u32 s47, s47, 57344
    s_add_u32 m0, s48, 0
    s_nop 0
    buffer_load_dwordx4 v4, s[64:67], s47 offen lds
    s_add_u32 m0, s48, 32768
    s_add_u32 s48, s48, 1024
    buffer_load_dwordx4 v4, s[68:71], s47 offen lds
    s_add_u32 s47, s47, 57344
    s_add_u32 m0, s48, 0
    s_nop 0
    buffer_load_dwordx4 v4, s[64:67], s47 offen lds
    s_add_u32 m0, s48, 32768
    s_add_u32 s48, s48, 1024
    buffer_load_dwordx4 v4, s[68:71], s47 offen lds
    s_add_u32 s47, s47, 57344
K2_top_nodma:
    v_max3_u32 v11, v16, v17, v18
    v_max3_u32 v12, v19, v20, v21
    v_max3_u32 v11, v22, v23, v11
    v_max3_u32 v12, v24, v25, v12
    v_max3_u32 v11, v26, v27, v11
    v_max3_u32 v12, v28, v29, v12
    v_max3_u32 v11, v30, v31, v11
    v_max3_u32 v12, v32, v33, v12
    v_max3_u32 v11, v34, v35, v11
    v_max3_u32 v12, v36, v37, v12
    v_max3_u32 v11, v38, v39, v11
    v_max3_u32 v12, v40, v41, v12
    v_max3_u32 v11, v42, v43, v11
    v_max3_u32 v12, v44, v45, v12
    v_max3_u32 v11, v46, v47, v11
    v_max_u32 v11, v11, v12
    s_nop 1
    v_max_u32_dpp v11, v11, v11 row_shr:1
    s_nop 1
    v_max_u32_dpp v11, v11, v11 row_shr:2
    s_nop 1
    v_max_u32_dpp v11, v11, v11 row_shr:4
    s_nop 1
    v_max_u32_dpp v11, v11, v11 row_shr:8
    s_nop 1
    v_max_u32_dpp v11, v11, v11 row_bcast:15 row_mask:0xa
    s_nop 1
    v_max_u32_dpp v11, v11, v11 row_bcast:31 row_mask:0xc
    s_nop 1
    v_readlane_b32 s53, v11, 63
    s_lshl_b64 exec, 1, s49
    s_nop 0
    s_and_b32 s54, s53, 0x7ff
    v_mov_b32 v10, s53
    s_mov_b32 exec_lo, -1
    s_mov_b32 exec_hi, 0
    s_sub_u32 s54, 2047, s54
    s_lshl_b32 s55, s54, 11
    s_mov_b32 m0, s52
    s_add_u32 s55, s55, s75
    buffer_load_dwordx4 v3, s[36:39], s55 offen lds
    s_lshr_b32 s72, s54, 8
    s_add_u32 s52, s52, 528
    s_lshl_b32 s72, s72, 2
    s_and_b32 s73, s54, 3
    s_add_u32 s72, s72, s73
    s_bfe_u32 s73, s54, 0x60002
    s_lshl_b64 exec, 1, s73
    s_set_gpr_idx_on s72, 0x8
    v_mov_b32 v16, 0
    s_set_gpr_idx_off
    s_mov_b64 exec, -1
    s_add_u32 s49, s49, 1
    s_cmp_lt_u32 s49, 8
    s_cbranch_scc1 K2_top
    v_lshrrev_b32 v13, 4, v1
    v_and_b32 v12, 15, v1
    v_xor_b32 v12, v12, v13
    s_lshl_b32 s53, s40, 6
    v_add_u32 v13, s53, v13
    v_lshlrev_b32 v13, 11, v13
    s_lshl_b32 s53, s41, 8
    v_add_u32 v13, s53, v13
    v_lshl_add_u32 v16, v12, 4, v13
    v_xor_b32 v17, 64, v16
    v_xor_b32 v18, 128, v16
    v_xor_b32 v19, 192, v16
    v_add_u32 v17, 0x1c00, v17
    v_add_u32 v18, 0x3800, v18
    v_add_u32 v19, 0x5400, v19
    s_waitcnt vmcnt(0)
    v_mov_b32 v14, 1
    v_mov_b32 v15, 152708
    ds_write_b32 v15, v14
    s_mov_b32 m0, 131072
    s_mov_b32 s47, 0
    buffer_load_dwordx4 v16, s[36:39], s47 offen offset:0 lds
    buffer_load_dwordx4 v17, s[36:39], s47 offen offset:1024 lds
    buffer_load_dwordx4 v18, s[36:39], s47 offen offset:2048 lds
    buffer_load_dwordx4 v19, s[36:39], s47 offen offset:3072 lds
    s_mov_b32 m0, 135168
    s_mov_b32 s47, 32768
    buffer_load_dwordx4 v16, s[36:39], s47 offen offset:0 lds
    buffer_load_dwordx4 v17, s[36:39], s47 offen offset:1024 lds
    buffer_load_dwordx4 v18, s[36:39], s47 offen offset:2048 lds
    buffer_load_dwordx4 v19, s[36:39], s47 offen offset:3072 lds
    s_mov_b32 m0, 139264
    s_mov_b32 s47, 65536
    buffer_load_dwordx4 v16, s[36:39], s47 offen offset:0 lds
    buffer_load_dwordx4 v17, s[36:39], s47 offen offset:1024 lds
    buffer_load_dwordx4 v18, s[36:39], s47 offen offset:2048 lds
    buffer_load_dwordx4 v19, s[36:39], s47 offen offset:3072 lds
    s_mov_b32 m0, 143360
    s_mov_b32 s47, 98304
    buffer_load_dwordx4 v16, s[36:39], s47 offen offset:0 lds
    buffer_load_dwordx4 v17, s[36:39], s47 offen offset:1024 lds
    buffer_load_dwordx4 v18, s[36:39], s47 offen offset:2048 lds
    buffer_load_dwordx4 v19, s[36:39], s47 offen offset:3072 lds
    s_waitcnt vmcnt(0) lgkmcnt(0)
    s_mov_b32 s49, 0
Y_slot:
    v_readlane_b32 s53, v10, s49
    s_nop 3
    s_and_b32 s54, s53, 0x7ff
    s_sub_u32 s54, 2047, s54
    s_lshr_b32 s55, s54, 6
    s_cmp_lg_u32 s55, s40
    s_cbranch_scc1 Y_next
    s_and_b32 s55, s53, 0xffff0000
    s_ashr_i32 s56, s55, 31
    s_not_b32 s56, s56
    s_or_b32 s56, s56, 0x80000000
    s_xor_b32 s55, s55, s56
    s_and_b32 s55, s55, 0xffff0000
    v_mov_b32 v11, s55
    v_mul_f32 v11, 0xbfb8aa3b, v11
    v_exp_f32 v11, v11
    s_and_b32 s54, s54, 63
    s_lshl_b32 s55, s49, 12
    s_lshl_b32 s56, s41, 9
    s_add_u32 s55, s55, s56
    s_add_u32 s55, s55, 11010048
    v_add_f32 v11, 1.0, v11
    v_rcp_f32 v11, v11
    v_lshlrev_b32 v12, 3, v1
    v_lshrrev_b32 v13, 2, v1
    s_and_b32 s58, s54, 15
    v_xor_b32 v13, s58, v13
    v_lshlrev_b32 v13, 4, v13
    v_and_b32 v14, 3, v1
    v_lshl_add_u32 v13, v14, 2, v13
    s_lshl_b32 s58, s54, 8
    s_add_u32 s58, s58, 131072
    v_add_u32 v13, s58, v13
    ds_read_b32 v15, v13
    s_mov_b32 s60, 0
Y_poll:
    s_mov_b32 s56, s55
    buffer_load_dwordx2 v[16:17], v12, s[32:35], s56 offen sc1
    s_add_u32 s56, s56, 0x8000
    buffer_load_dwordx2 v[18:19], v12, s[32:35], s56 offen sc1
    s_add_u32 s56, s56, 0x8000
    buffer_load_dwordx2 v[20:21], v12, s[32:35], s56 offen sc1
    s_add_u32 s56, s56, 0x8000
    buffer_load_dwordx2 v[22:23], v12, s[32:35], s56 offen sc1
    s_add_u32 s56, s56, 0x8000
    buffer_load_dwordx2 v[24:25], v12, s[32:35], s56 offen sc1
    s_add_u32 s56, s56, 0x8000
    buffer_load_dwordx2 v[26:27], v12, s[32:35], s56 offen sc1
    s_add_u32 s56, s56, 0x8000
    buffer_load_dwordx2 v[28:29], v12, s[32:35], s56 offen sc1
    s_add_u32 s56, s56, 0x8000
    buffer_load_dwordx2 v[30:31], v12, s[32:35], s56 offen sc1
    s_add_u32 s56, s56, 0x8000
    buffer_load_dwordx2 v[32:33], v12, s[32:35], s56 offen sc1
    s_add_u32 s56, s56, 0x8000
    buffer_load_dwordx2 v[34:35], v12, s[32:35], s56 offen sc1
    s_add_u32 s56, s56, 0x8000
    buffer_load_dwordx2 v[36:37], v12, s[32:35], s56 offen sc1
    s_add_u32 s56, s56, 0x8000
    buffer_load_dwordx2 v[38:39], v12, s[32:35], s56 offen sc1
    s_add_u32 s56, s56, 0x8000
    buffer_load_dwordx2 v[40:41], v12, s[32:35], s56 offen sc1
    s_add_u32 s56, s56, 0x8000
    buffer_load_dwordx2 v[42:43], v12, s[32:35], s56 offen sc1
    s_waitcnt vmcnt(0) lgkmcnt(0)
    v_max3_u32 v14, v16, v17, v18
    v_max3_u32 v14, v19, v20, v14
    v_max3_u32 v14, v21, v22, v14
    v_max3_u32 v14, v23, v24, v14
    v_max3_u32 v14, v25, v26, v14
    v_max3_u32 v14, v27, v28, v14
    v_max3_u32 v14, v29, v30, v14
    v_max3_u32 v14, v31, v32, v14
    v_max3_u32 v14, v33, v34, v14
    v_max3_u32 v14, v35, v36, v14
    v_max3_u32 v14, v37, v38, v14
    v_max3_u32 v14, v39, v40, v14
    v_max3_u32 v14, v41, v42, v14
    v_max_u32 v14, v43, v14
    v_cmp_eq_u32 vcc, -1, v14
    s_add_u32 s60, s60, 1
    s_cmp_ge_u32 s60, 131072
    s_cbranch_scc1 Y_go
    s_cbranch_vccz Y_go
    s_sleep 32
    s_branch Y_poll
Y_go:
    v_pk_add_f32 v[16:17], v[16:17], v[18:19]
    v_pk_add_f32 v[16:17], v[16:17], v[20:21]
    v_pk_add_f32 v[16:17], v[16:17], v[22:23]
    v_pk_add_f32 v[16:17], v[16:17], v[24:25]
    v_pk_add_f32 v[16:17], v[16:17], v[26:27]
    v_pk_add_f32 v[16:17], v[16:17], v[28:29]
    v_pk_add_f32 v[16:17], v[16:17], v[30:31]
    v_pk_add_f32 v[16:17], v[16:17], v[32:33]
    v_pk_add_f32 v[16:17], v[16:17], v[34:35]
    v_pk_add_f32 v[16:17], v[16:17], v[36:37]
    v_pk_add_f32 v[16:17], v[16:17], v[38:39]
    v_pk_add_f32 v[16:17], v[16:17], v[40:41]
    v_pk_add_f32 v[16:17], v[16:17], v[42:43]
    v_lshlrev_b32 v14, 16, v15
    v_and_b32 v15, 0xffff0000, v15
    v_fmac_f32 v14, v16, v11
    v_fmac_f32 v15, v17, v11
    v_cvt_pk_bf16_f32 v15, v14, v15
    ds_write_b32 v13, v15
Y_next:
    s_add_u32 s49, s49, 1
    s_cmp_lt_u32 s49, 8
    s_cbranch_scc1 Y_slot
    s_waitcnt lgkmcnt(0)
    s_branch K_p3ld
K_A2:
    s_setprio 0
    s_cmp_eq_u32 s61, 0
    s_cbranch_scc1 K_wpf
    s_mov_b32 s49, 0
    v_mov_b32 v15, 152708
K2_wA1:
    s_sleep 16
    ds_read_b32 v14, v15
    s_waitcnt lgkmcnt(0)
    v_readfirstlane_b32 s57, v14
    s_nop 0
    s_cmp_eq_u32 s57, 0
    s_cbranch_scc1 K2_wA1
K2_up:
    ds_read_b128 v[48:51], v13
    ds_read_b64_tr_b16 v[52:53], v12 offset:0
    ds_read_b64_tr_b16 v[54:55], v12 offset:512
    ds_read_b64_tr_b16 v[56:57], v12 offset:32768
    ds_read_b64_tr_b16 v[58:59], v12 offset:33280
    ds_read_b64_tr_b16 v[60:61], v12 offset:32
    ds_read_b64_tr_b16 v[62:63], v12 offset:544
    ds_read_b64_tr_b16 v[64:65], v12 offset:32800
    ds_read_b64_tr_b16 v[66:67], v12 offset:33312
    ds_read_b64_tr_b16 v[68:69], v12 offset:64
    ds_read_b64_tr_b16 v[70:71], v12 offset:576
    s_waitcnt lgkmcnt(8)
    v_mfma_f32_16x16x32_bf16 v[16:19], v[52:55], v[48:51], v[16:19]
    ds_read_b64_tr_b16 v[72:73], v12 offset:32832
    ds_read_b64_tr_b16 v[74:75], v12 offset:33344
    s_waitcnt lgkmcnt(8)
    v_mfma_f32_16x16x32_bf16 v[20:23], v[56:59], v[48:51], v[20:23]
    ds_read_b64_tr_b16 v[76:77], v12 offset:96
    ds_read_b64_tr_b16 v[78:79], v12 offset:608
    s_waitcnt lgkmcnt(8)
    v_mfma_f32_16x16x32_bf16 v[24:27], v[60:63], v[48:51], v[24:27]
    ds_read_b64_tr_b16 v[80:81], v12 offset:32864
    ds_read_b64_tr_b16 v[82:83], v12 offset:33376
    s_waitcnt lgkmcnt(8)
    v_mfma_f32_16x16x32_bf16 v[28:31], v[64:67], v[48:51], v[28:31]
    v_add_u32 v12, 4096, v12
    v_add_u32 v13, 64, v13
    s_add_u32 s49, s49, 1
    s_cmp_lt_u32 s49, 8
    s_waitcnt lgkmcnt(6)
    v_mfma_f32_16x16x32_bf16 v[32:35], v[68:71], v[48:51], v[32:35]
    s_waitcnt lgkmcnt(4)
    v_mfma_f32_16x16x32_bf16 v[36:39], v[72:75], v[48:51], v[36:39]
    s_waitcnt lgkmcnt(2)
    v_mfma_f32_16x16x32_bf16 v[40:43], v[76:79], v[48:51], v[40:43]
    s_waitcnt lgkmcnt(0)
    v_mfma_f32_16x16x32_bf16 v[44:47], v[80:83], v[48:51], v[44:47]
    s_cbranch_scc1 K2_up
    v_mov_b32 v14, 1
    v_mov_b32 v15, 152712
    ds_write_b32 v15, v14
    s_andn2_b32 s48, s62, 3
    s_lshl_b32 s48, s48, 12
    s_and_b32 s47, s62, 3
    s_lshl_b32 s47, s47, 10
    s_add_u32 s48, s48, s47
    s_add_u32 s48, s48, 11534336
    s_mov_b32 exec_lo, 0x00ff00ff
    s_mov_b32 exec_hi, 0x00ff00ff
    buffer_store_dwordx4 v[16:19], v11, s[32:35], s48 offen offset:0 sc1
    buffer_store_dwordx4 v[20:23], v11, s[32:35], s48 offen offset:512 sc1
    s_add_u32 s48, s48, 0x1000
    buffer_store_dwordx4 v[24:27], v11, s[32:35], s48 offen offset:0 sc1
    buffer_store_dwordx4 v[28:31], v11, s[32:35], s48 offen offset:512 sc1
    s_add_u32 s48, s48, 0x1000
    buffer_store_dwordx4 v[32:35], v11, s[32:35], s48 offen offset:0 sc1
    buffer_store_dwordx4 v[36:39], v11, s[32:35], s48 offen offset:512 sc1
    s_add_u32 s48, s48, 0x1000
    buffer_store_dwordx4 v[40:43], v11, s[32:35], s48 offen offset:0 sc1
    buffer_store_dwordx4 v[44:47], v11, s[32:35], s48 offen offset:512 sc1
    s_mov_b64 exec, -1
    s_waitcnt lgkmcnt(0)
K_wpf:
    s_mov_b32 s36, s12
    s_mov_b32 s37, s13
    s_mov_b32 s38, 0x200000
    s_mov_b32 s39, 0x00020000
    v_lshrrev_b32 v13, 4, v1
    v_lshlrev_b32 v14, 2, v13
    v_and_b32 v15, 15, v1
    v_xor_b32 v14, v14, v15
    v_lshlrev_b32 v8, 11, v13
    v_lshl_add_u32 v8, v14, 4, v8
    s_lshl_b32 s53, s41, 8
    v_add_u32 v8, s53, v8
    v_add_u32 v9, 0x1c00, v8
    v_add_u32 v10, 0x3800, v8
    v_add_u32 v11, 0x5400, v8
    s_and_b32 s54, s40, 7
    s_mul_i32 s54, s54, 7
    s_lshl_b32 s48, s41, 3
    s_add_u32 s54, s54, s48
    s_add_u32 s54, s54, 16
    s_mov_b32 m0, 152768
    s_mov_b32 s49, 0
K_wpf_l:
    s_and_b32 s55, s54, 63
    s_lshl_b32 s55, s55, 15
    s_waitcnt vmcnt(4)
    buffer_load_dwordx4 v8, s[36:39], s55 offen offset:0 lds
    buffer_load_dwordx4 v9, s[36:39], s55 offen offset:1024 lds
    buffer_load_dwordx4 v10, s[36:39], s55 offen offset:2048 lds
    buffer_load_dwordx4 v11, s[36:39], s55 offen offset:3072 lds
    s_add_u32 s54, s54, 1
    s_add_u32 s49, s49, 1
    s_cmp_lt_u32 s49, 7
    s_cbranch_scc1 K_wpf_l
    s_mov_b32 s45, 0x8000
    s_mov_b32 s48, 8
    s_mov_b32 s50, 0
    s_branch K_w8
K_A1:
    s_setprio 0
    s_cmp_eq_u32 s61, 0
    s_cbranch_scc1 K2_wo
    s_mov_b32 s64, s22
    s_mov_b32 s65, s23
    s_mov_b32 s66, 0x700000
    s_mov_b32 s67, 0x00020000
    s_lshr_b32 s72, s62, 4
    s_and_b32 s73, s62, 15
    s_lshl_b32 s47, s72, 19
    s_lshl_b32 s48, s73, 7
    s_add_u32 s47, s47, s48
    v_lshrrev_b32 v4, 3, v1
    v_lshlrev_b32 v4, 11, v4
    v_and_b32 v5, 7, v1
    v_lshl_add_u32 v4, v5, 4, v4
    v_lshrrev_b32 v7, 4, v1
    v_lshl_add_u32 v13, v7, 3, v5
    v_lshlrev_b32 v13, 4, v13
    v_bfe_u32 v8, v1, 2, 2
    v_lshl_add_u32 v12, v7, 2, v8
    v_lshlrev_b32 v12, 7, v12
    v_and_b32 v9, 3, v1
    v_lshl_add_u32 v12, v9, 3, v12
    v_mov_b32 v15, 152712
K2_wA2:
    s_sleep 8
    ds_read_b32 v14, v15
    s_waitcnt lgkmcnt(0)
    v_readfirstlane_b32 s57, v14
    s_nop 0
    s_cmp_eq_u32 s57, 0
    s_cbranch_scc1 K2_wA2
    s_mov_b32 m0, 0
    s_mov_b32 s49, 0
K2_dn_dma:
    s_waitcnt vmcnt(20)
    buffer_load_dwordx4 v4, s[64:67], s47 offen lds
    s_add_u32 m0, m0, 1024
    s_add_u32 s47, s47, 0x4000
    s_add_u32 s49, s49, 1
    s_cmp_lt_u32 s49, 32
    s_cbranch_scc1 K2_dn_dma
    s_lshl_b32 s48, s62, 12
    s_add_u32 s48, s48, 11534336
    s_mov_b32 s49, 0
K2_px:
    buffer_load_dwordx4 v[16:19], v13, s[32:35], s48 offen offset:0 sc1
    buffer_load_dwordx4 v[20:23], v13, s[32:35], s48 offen offset:512 sc1
    buffer_load_dwordx4 v[24:27], v13, s[32:35], s48 offen offset:1024 sc1
    buffer_load_dwordx4 v[28:31], v13, s[32:35], s48 offen offset:1536 sc1
    buffer_load_dwordx4 v[32:35], v13, s[32:35], s48 offen offset:2048 sc1
    buffer_load_dwordx4 v[36:39], v13, s[32:35], s48 offen offset:2560 sc1
    buffer_load_dwordx4 v[40:43], v13, s[32:35], s48 offen offset:3072 sc1
    buffer_load_dwordx4 v[44:47], v13, s[32:35], s48 offen offset:3584 sc1
    s_waitcnt vmcnt(0)
    v_max3_u32 v14, v16, v17, v18
    v_max3_u32 v14, v19, v20, v14
    v_max3_u32 v14, v21, v22, v14
    v_max3_u32 v14, v23, v24, v14
    v_max3_u32 v14, v25, v26, v14
    v_max3_u32 v14, v27, v28, v14
    v_max3_u32 v14, v29, v30, v14
    v_max3_u32 v14, v31, v32, v14
    v_max3_u32 v14, v33, v34, v14
    v_max3_u32 v14, v35, v36, v14
    v_max3_u32 v14, v37, v38, v14
    v_max3_u32 v14, v39, v40, v14
    v_max3_u32 v14, v41, v42, v14
    v_max3_u32 v14, v43, v44, v14
    v_max3_u32 v14, v45, v46, v14
    v_max_u32 v14, v47, v14
    v_cmp_eq_u32 vcc, -1, v14
    s_add_u32 s49, s49, 1
    s_cmp_ge_u32 s49, 131072
    s_cbranch_scc1 K2_px_done
    s_cbranch_vccz K2_px_done
    s_sleep 10
    s_branch K2_px
K2_px_done:
    v_add_f32 v16, v16, v24
    v_add_f32 v17, v17, v25
    v_add_f32 v18, v18, v26
    v_add_f32 v19, v19, v27
    v_add_f32 v20, v20, v28
    v_add_f32 v21, v21, v29
    v_add_f32 v22, v22, v30
    v_add_f32 v23, v23, v31
    v_add_f32 v32, v32, v40
    v_add_f32 v33, v33, v41
    v_add_f32 v34, v34, v42
    v_add_f32 v35, v35, v43
    v_add_f32 v36, v36, v44
    v_add_f32 v37, v37, v45
    v_add_f32 v38, v38, v46
    v_add_f32 v39, v39, v47
    v_add_f32 v16, v16, v32
    v_add_f32 v17, v17, v33
    v_add_f32 v18, v18, v34
    v_add_f32 v19, v19, v35
    v_add_f32 v20, v20, v36
    v_add_f32 v21, v21, v37
    v_add_f32 v22, v22, v38
    v_add_f32 v23, v23, v39
    v_mul_f32 v24, 0xbfb8aa3b, v16
    v_mul_f32 v25, 0xbfb8aa3b, v17
    v_mul_f32 v26, 0xbfb8aa3b, v18
    v_mul_f32 v27, 0xbfb8aa3b, v19
    v_exp_f32 v24, v24
    v_exp_f32 v25, v25
    v_exp_f32 v26, v26
    v_exp_f32 v27, v27
    v_add_f32 v24, 1.0, v24
    v_add_f32 v25, 1.0, v25
    v_add_f32 v26, 1.0, v26
    v_add_f32 v27, 1.0, v27
    v_rcp_f32 v24, v24
    v_rcp_f32 v25, v25
    v_rcp_f32 v26, v26
    v_rcp_f32 v27, v27
    v_mul_f32 v16, v16, v20
    v_mul_f32 v17, v17, v21
    v_mul_f32 v18, v18, v22
    v_mul_f32 v19, v19, v23
    v_mul_f32 v16, v16, v24
    v_mul_f32 v17, v17, v25
    v_mul_f32 v18, v18, v26
    v_mul_f32 v19, v19, v27
    v_cvt_pk_bf16_f32 v48, v16, v17
    v_cvt_pk_bf16_f32 v49, v18, v19
    v_min_u32 v48, -2, v48
    v_min_u32 v49, -2, v49
    s_lshr_b32 s48, s62, 1
    s_lshl_b32 s48, s48, 9
    s_and_b32 s47, s62, 1
    s_lshl_b32 s47, s47, 3
    s_add_u32 s48, s48, s47
    s_add_u32 s48, s48, 10846208
    s_mov_b32 exec_lo, 0x00ff00ff
    s_mov_b32 exec_hi, 0x00ff00ff
    buffer_store_dwordx2 v[48:49], v13, s[32:35], s48 offen sc1
    s_mov_b64 exec, -1
    s_lshl_b32 s48, s72, 12
    s_add_u32 s48, s48, 10846208
    s_mov_b32 s49, 0
K2_hx:
    buffer_load_dwordx4 v[16:19], v13, s[32:35], s48 offen offset:0 sc1
    buffer_load_dwordx4 v[20:23], v13, s[32:35], s48 offen offset:512 sc1
    buffer_load_dwordx4 v[24:27], v13, s[32:35], s48 offen offset:1024 sc1
    buffer_load_dwordx4 v[28:31], v13, s[32:35], s48 offen offset:1536 sc1
    buffer_load_dwordx4 v[32:35], v13, s[32:35], s48 offen offset:2048 sc1
    buffer_load_dwordx4 v[36:39], v13, s[32:35], s48 offen offset:2560 sc1
    buffer_load_dwordx4 v[40:43], v13, s[32:35], s48 offen offset:3072 sc1
    buffer_load_dwordx4 v[44:47], v13, s[32:35], s48 offen offset:3584 sc1
    s_waitcnt vmcnt(0)
    v_max3_u32 v14, v16, v17, v18
    v_max3_u32 v14, v19, v20, v14
    v_max3_u32 v14, v21, v22, v14
    v_max3_u32 v14, v23, v24, v14
    v_max3_u32 v14, v25, v26, v14
    v_max3_u32 v14, v27, v28, v14
    v_max3_u32 v14, v29, v30, v14
    v_max3_u32 v14, v31, v32, v14
    v_max3_u32 v14, v33, v34, v14
    v_max3_u32 v14, v35, v36, v14
    v_max3_u32 v14, v37, v38, v14
    v_max3_u32 v14, v39, v40, v14
    v_max3_u32 v14, v41, v42, v14
    v_max3_u32 v14, v43, v44, v14
    v_max3_u32 v14, v45, v46, v14
    v_max_u32 v14, v47, v14
    v_cmp_eq_u32 vcc, -1, v14
    s_add_u32 s49, s49, 1
    s_cmp_ge_u32 s49, 131072
    s_cbranch_scc1 K2_hx_done
    s_cbranch_vccz K2_hx_done
    s_sleep 10
    s_branch K2_hx
K2_hx_done:
    ds_read_b64_tr_b16 v[64:65], v12 offset:0
    ds_read_b64_tr_b16 v[66:67], v12 offset:2048
    ds_read_b64_tr_b16 v[68:69], v12 offset:32
    ds_read_b64_tr_b16 v[70:71], v12 offset:2080
    ds_read_b64_tr_b16 v[72:73], v12 offset:64
    ds_read_b64_tr_b16 v[74:75], v12 offset:2112
    ds_read_b64_tr_b16 v[76:77], v12 offset:96
    ds_read_b64_tr_b16 v[78:79], v12 offset:2144
    ds_read_b64_tr_b16 v[80:81], v12 offset:4096
    ds_read_b64_tr_b16 v[82:83], v12 offset:6144
    s_waitcnt lgkmcnt(8)
    v_mfma_f32_16x16x32_bf16 v[96:99], v[16:19], v[64:67], 0
    ds_read_b64_tr_b16 v[84:85], v12 offset:4128
    ds_read_b64_tr_b16 v[86:87], v12 offset:6176
    s_waitcnt lgkmcnt(8)
    v_mfma_f32_16x16x32_bf16 v[100:103], v[16:19], v[68:71], 0
    ds_read_b64_tr_b16 v[88:89], v12 offset:4160
    ds_read_b64_tr_b16 v[90:91], v12 offset:6208
    s_waitcnt lgkmcnt(8)
    v_mfma_f32_16x16x32_bf16 v[104:107], v[16:19], v[72:75], 0
    ds_read_b64_tr_b16 v[92:93], v12 offset:4192
    ds_read_b64_tr_b16 v[94:95], v12 offset:6240
    s_waitcnt lgkmcnt(8)
    v_mfma_f32_16x16x32_bf16 v[108:111], v[16:19], v[76:79], 0
    ds_read_b64_tr_b16 v[64:65], v12 offset:8192
    ds_read_b64_tr_b16 v[66:67], v12 offset:10240
    s_waitcnt lgkmcnt(8)
    v_mfma_f32_16x16x32_bf16 v[96:99], v[20:23], v[80:83], v[96:99]
    ds_read_b64_tr_b16 v[68:69], v12 offset:8224
    ds_read_b64_tr_b16 v[70:71], v12 offset:10272
    s_waitcnt lgkmcnt(8)
    v_mfma_f32_16x16x32_bf16 v[100:103], v[20:23], v[84:87], v[100:103]
    ds_read_b64_tr_b16 v[72:73], v12 offset:8256
    ds_read_b64_tr_b16 v[74:75], v12 offset:10304
    s_waitcnt lgkmcnt(8)
    v_mfma_f32_16x16x32_bf16 v[104:107], v[20:23], v[88:91], v[104:107]
    ds_read_b64_tr_b16 v[76:77], v12 offset:8288
    ds_read_b64_tr_b16 v[78:79], v12 offset:10336
    s_waitcnt lgkmcnt(8)
    v_mfma_f32_16x16x32_bf16 v[108:111], v[20:23], v[92:95], v[108:111]
    ds_read_b64_tr_b16 v[80:81], v12 offset:12288
    ds_read_b64_tr_b16 v[82:83], v12 offset:14336
    s_waitcnt lgkmcnt(8)
    v_mfma_f32_16x16x32_bf16 v[96:99], v[24:27], v[64:67], v[96:99]
    ds_read_b64_tr_b16 v[84:85], v12 offset:12320
    ds_read_b64_tr_b16 v[86:87], v12 offset:14368
    s_waitcnt lgkmcnt(8)
    v_mfma_f32_16x16x32_bf16 v[100:103], v[24:27], v[68:71], v[100:103]
    ds_read_b64_tr_b16 v[88:89], v12 offset:12352
    ds_read_b64_tr_b16 v[90:91], v12 offset:14400
    s_waitcnt lgkmcnt(8)
    v_mfma_f32_16x16x32_bf16 v[104:107], v[24:27], v[72:75], v[104:107]
    ds_read_b64_tr_b16 v[92:93], v12 offset:12384
    ds_read_b64_tr_b16 v[94:95], v12 offset:14432
    s_waitcnt lgkmcnt(8)
    v_mfma_f32_16x16x32_bf16 v[108:111], v[24:27], v[76:79], v[108:111]
    ds_read_b64_tr_b16 v[64:65], v12 offset:16384
    ds_read_b64_tr_b16 v[66:67], v12 offset:18432
    s_waitcnt lgkmcnt(8)
    v_mfma_f32_16x16x32_bf16 v[96:99], v[28:31], v[80:83], v[96:99]
    ds_read_b64_tr_b16 v[68:69], v12 offset:16416
    ds_read_b64_tr_b16 v[70:71], v12 offset:18464
    s_waitcnt lgkmcnt(8)
    v_mfma_f32_16x16x32_bf16 v[100:103], v[28:31], v[84:87], v[100:103]
    ds_read_b64_tr_b16 v[72:73], v12 offset:16448
    ds_read_b64_tr_b16 v[74:75], v12 offset:18496
    s_waitcnt lgkmcnt(8)
    v_mfma_f32_16x16x32_bf16 v[104:107], v[28:31], v[88:91], v[104:107]
    ds_read_b64_tr_b16 v[76:77], v12 offset:16480
    ds_read_b64_tr_b16 v[78:79], v12 offset:18528
    s_waitcnt lgkmcnt(8)
    v_mfma_f32_16x16x32_bf16 v[108:111], v[28:31], v[92:95], v[108:111]
    ds_read_b64_tr_b16 v[80:81], v12 offset:20480
    ds_read_b64_tr_b16 v[82:83], v12 offset:22528
    s_waitcnt lgkmcnt(8)
    v_mfma_f32_16x16x32_bf16 v[96:99], v[32:35], v[64:67], v[96:99]
    ds_read_b64_tr_b16 v[84:85], v12 offset:20512
    ds_read_b64_tr_b16 v[86:87], v12 offset:22560
    s_waitcnt lgkmcnt(8)
    v_mfma_f32_16x16x32_bf16 v[100:103], v[32:35], v[68:71], v[100:103]
    ds_read_b64_tr_b16 v[88:89], v12 offset:20544
    ds_read_b64_tr_b16 v[90:91], v12 offset:22592
    s_waitcnt lgkmcnt(8)
    v_mfma_f32_16x16x32_bf16 v[104:107], v[32:35], v[72:75], v[104:107]
    ds_read_b64_tr_b16 v[92:93], v12 offset:20576
    ds_read_b64_tr_b16 v[94:95], v12 offset:22624
    s_waitcnt lgkmcnt(8)
    v_mfma_f32_16x16x32_bf16 v[108:111], v[32:35], v[76:79], v[108:111]
    ds_read_b64_tr_b16 v[64:65], v12 offset:24576
    ds_read_b64_tr_b16 v[66:67], v12 offset:26624
    s_waitcnt lgkmcnt(8)
    v_mfma_f32_16x16x32_bf16 v[96:99], v[36:39], v[80:83], v[96:99]
    ds_read_b64_tr_b16 v[68:69], v12 offset:24608
    ds_read_b64_tr_b16 v[70:71], v12 offset:26656
    s_waitcnt lgkmcnt(8)
    v_mfma_f32_16x16x32_bf16 v[100:103], v[36:39], v[84:87], v[100:103]
    ds_read_b64_tr_b16 v[72:73], v12 offset:24640
    ds_read_b64_tr_b16 v[74:75], v12 offset:26688
    s_waitcnt lgkmcnt(8)
    v_mfma_f32_16x16x32_bf16 v[104:107], v[36:39], v[88:91], v[104:107]
    ds_read_b64_tr_b16 v[76:77], v12 offset:24672
    ds_read_b64_tr_b16 v[78:79], v12 offset:26720
    s_waitcnt lgkmcnt(8)
    v_mfma_f32_16x16x32_bf16 v[108:111], v[36:39], v[92:95], v[108:111]
    ds_read_b64_tr_b16 v[80:81], v12 offset:28672
    ds_read_b64_tr_b16 v[82:83], v12 offset:30720
    s_waitcnt lgkmcnt(8)
    v_mfma_f32_16x16x32_bf16 v[96:99], v[40:43], v[64:67], v[96:99]
    ds_read_b64_tr_b16 v[84:85], v12 offset:28704
    ds_read_b64_tr_b16 v[86:87], v12 offset:30752
    s_waitcnt lgkmcnt(8)
    v_mfma_f32_16x16x32_bf16 v[100:103], v[40:43], v[68:71], v[100:103]
    ds_read_b64_tr_b16 v[88:89], v12 offset:28736
    ds_read_b64_tr_b16 v[90:91], v12 offset:30784
    s_waitcnt lgkmcnt(8)
    v_mfma_f32_16x16x32_bf16 v[104:107], v[40:43], v[72:75], v[104:107]
    ds_read_b64_tr_b16 v[92:93], v12 offset:28768
    ds_read_b64_tr_b16 v[94:95], v12 offset:30816
    s_waitcnt lgkmcnt(8)
    v_mfma_f32_16x16x32_bf16 v[108:111], v[40:43], v[76:79], v[108:111]
    s_waitcnt lgkmcnt(6)
    v_mfma_f32_16x16x32_bf16 v[96:99], v[44:47], v[80:83], v[96:99]
    s_waitcnt lgkmcnt(4)
    v_mfma_f32_16x16x32_bf16 v[100:103], v[44:47], v[84:87], v[100:103]
    s_waitcnt lgkmcnt(2)
    v_mfma_f32_16x16x32_bf16 v[104:107], v[44:47], v[88:91], v[104:107]
    s_waitcnt lgkmcnt(0)
    v_mfma_f32_16x16x32_bf16 v[108:111], v[44:47], v[92:95], v[108:111]
    s_lshl_b32 s47, s72, 15
    s_lshl_b32 s48, s73, 8
    s_add_u32 s47, s47, s48
    s_add_u32 s47, s47, 11010048
    v_and_b32 v5, 15, v1
    v_lshlrev_b32 v5, 2, v5
    v_lshl_add_u32 v5, v7, 14, v5
    s_mov_b32 exec_hi, 0
    buffer_store_dword v96, v5, s[32:35], s47 offen offset:0 sc1
    buffer_store_dword v100, v5, s[32:35], s47 offen offset:64 sc1
    buffer_store_dword v104, v5, s[32:35], s47 offen offset:128 sc1
    buffer_store_dword v108, v5, s[32:35], s47 offen offset:192 sc1
    s_add_u32 s47, s47, 0x1000
    buffer_store_dword v97, v5, s[32:35], s47 offen offset:0 sc1
    buffer_store_dword v101, v5, s[32:35], s47 offen offset:64 sc1
    buffer_store_dword v105, v5, s[32:35], s47 offen offset:128 sc1
    buffer_store_dword v109, v5, s[32:35], s47 offen offset:192 sc1
    s_add_u32 s47, s47, 0x1000
    buffer_store_dword v98, v5, s[32:35], s47 offen offset:0 sc1
    buffer_store_dword v102, v5, s[32:35], s47 offen offset:64 sc1
    buffer_store_dword v106, v5, s[32:35], s47 offen offset:128 sc1
    buffer_store_dword v110, v5, s[32:35], s47 offen offset:192 sc1
    s_add_u32 s47, s47, 0x1000
    buffer_store_dword v99, v5, s[32:35], s47 offen offset:0 sc1
    buffer_store_dword v103, v5, s[32:35], s47 offen offset:64 sc1
    buffer_store_dword v107, v5, s[32:35], s47 offen offset:128 sc1
    buffer_store_dword v111, v5, s[32:35], s47 offen offset:192 sc1
    s_mov_b32 exec_hi, -1
K2_wo:
    s_mov_b32 s45, 0
    s_mov_b32 s48, 0
    s_mov_b32 s50, 0
K_w8:
    s_setprio 0
    s_mov_b32 s36, s12
    s_mov_b32 s37, s13
    s_mov_b32 s38, 0x200000
    s_mov_b32 s39, 0x00020000
    v_lshrrev_b32 v13, 4, v1
    v_lshlrev_b32 v14, 2, v13
    v_and_b32 v15, 15, v1
    v_xor_b32 v14, v14, v15
    v_lshlrev_b32 v8, 11, v13
    v_lshl_add_u32 v8, v14, 4, v8
    s_lshl_b32 s53, s41, 8
    v_add_u32 v8, s53, v8
    v_add_u32 v9, 0x1c00, v8
    v_add_u32 v10, 0x3800, v8
    v_add_u32 v11, 0x5400, v8
    v_and_b32 v20, 3, v1
    v_lshlrev_b32 v20, 8, v20
    v_add_u32 v20, 151680, v20
    s_lshl_b32 s47, s41, 3
    s_add_u32 s48, s48, s47
    s_mov_b32 s49, 0
    s_cmp_eq_u32 s50, 0
    s_cbranch_scc1 K2_wld
K2_wpoll:
    s_sleep 8
    ds_read_b32 v23, v20
    s_waitcnt lgkmcnt(0)
    v_cmp_gt_u32 vcc, s50, v23
    s_nop 1
    s_cbranch_vccnz K2_wpoll
    s_add_u32 s50, s50, 1
K2_wld:
    s_and_b32 s47, s48, 63
    s_mov_b32 m0, s45
    s_lshl_b32 s47, s47, 15
    s_waitcnt vmcnt(20)
    buffer_load_dwordx4 v8, s[36:39], s47 offen offset:0 lds
    buffer_load_dwordx4 v9, s[36:39], s47 offen offset:1024 lds
    buffer_load_dwordx4 v10, s[36:39], s47 offen offset:2048 lds
    buffer_load_dwordx4 v11, s[36:39], s47 offen offset:3072 lds
    s_add_u32 s48, s48, 1
    s_add_u32 s45, s45, 0x1000
    s_add_u32 s49, s49, 1
    s_cmp_eq_u32 s49, 8
    s_cbranch_scc1 K2_w8done
    s_cmp_lg_u32 s49, 4
    s_cbranch_scc1 K2_wld
    s_cmp_lg_u32 s50, 0
    s_cbranch_scc1 K2_wpoll
    s_branch K2_wld
K2_w8done:
    s_cmp_lg_u32 s45, 0x8000
    s_cbranch_scc1 K_p3ld
    s_mov_b32 s45, 0x18000
    s_add_u32 s48, s48, 8
    s_mov_b32 s49, 0
    s_mov_b32 s50, 13
    s_branch K2_wpoll
K_p3ld:
    s_setprio 0
    s_mov_b32 s36, s12
    s_mov_b32 s37, s13
    s_mov_b32 s38, 0x200000
    s_mov_b32 s39, 0x00020000
    v_lshrrev_b32 v13, 4, v1
    v_lshlrev_b32 v14, 2, v13
    v_and_b32 v15, 15, v1
    v_xor_b32 v14, v14, v15
    v_lshlrev_b32 v8, 11, v13
    v_lshl_add_u32 v8, v14, 4, v8
    s_lshl_b32 s53, s41, 8
    v_add_u32 v8, s53, v8
    v_add_u32 v9, 0x1c00, v8
    v_add_u32 v10, 0x3800, v8
    v_add_u32 v11, 0x5400, v8
    s_lshl_b32 s54, s42, 13
    v_add_u32 v8, s54, v8
    s_lshl_b32 s54, s42, 10
    s_lshl_b32 s50, s40, 8
    s_add_u32 s50, s50, 10838016
    s_lshl_b32 s51, s40, 17
    s_add_u32 s51, s51, 4194304
    s_add_u32 s51, s51, s54
    v_add_u32 v9, s51, v3
    v_add_u32 v10, 0x10000, v9
    s_lshl_b32 s52, s41, 13
    s_add_u32 s52, s52, 0x1000
    s_lshl_b32 s48, s41, 18
    s_add_u32 s48, s48, 753664
    v_lshlrev_b32 v4, 3, v1
    s_lshl_b32 s72, 1, s41
    s_xor_b32 s73, s72, 0xff
    s_mov_b32 s49, 0
    v_mov_b32 v30, s14
    v_mov_b32 v31, s15
    s_cmp_lg_u32 s42, 3
    s_waitcnt vmcnt(0)
    s_barrier
    s_barrier
    s_cbranch_scc1 O_noflag
    s_mov_b32 exec_hi, 0
    s_mov_b32 exec_lo, s72
    buffer_store_dwordx2 v[30:31], v4, s[32:35], s50 offen sc1
    s_mov_b64 exec, -1
O_noflag:
    s_barrier
    s_cbranch_scc1 O_noflag2
    s_mov_b32 exec_hi, 0
    s_mov_b32 exec_lo, s73
    buffer_load_dwordx2 v[6:7], v4, s[32:35], s50 offen sc1
    s_mov_b64 exec, -1
O_noflag2:
    s_add_u32 s48, s48, 0x8000
    s_add_u32 m0, s54, 0
    s_and_b32 s48, s48, 0x1fffff
    buffer_load_dwordx4 v8, s[36:39], s48 offen lds
    s_add_u32 s48, s48, 0x8000
    s_add_u32 m0, s54, 4096
    s_and_b32 s48, s48, 0x1fffff
    buffer_load_dwordx4 v8, s[36:39], s48 offen lds
    s_add_u32 s48, s48, 0x8000
    s_add_u32 m0, s54, 8192
    s_and_b32 s48, s48, 0x1fffff
    buffer_load_dwordx4 v8, s[36:39], s48 offen lds
    s_add_u32 s48, s48, 0x8000
    s_add_u32 m0, s54, 12288
    s_and_b32 s48, s48, 0x1fffff
    buffer_load_dwordx4 v8, s[36:39], s48 offen lds
    s_add_u32 s48, s48, 0x8000
    s_add_u32 m0, s54, 16384
    s_and_b32 s48, s48, 0x1fffff
    buffer_load_dwordx4 v8, s[36:39], s48 offen lds
    s_add_u32 s48, s48, 0x8000
    s_add_u32 m0, s54, 20480
    s_and_b32 s48, s48, 0x1fffff
    buffer_load_dwordx4 v8, s[36:39], s48 offen lds
    s_add_u32 s48, s48, 0x8000
    s_add_u32 m0, s54, 24576
    s_and_b32 s48, s48, 0x1fffff
    buffer_load_dwordx4 v8, s[36:39], s48 offen lds
    s_add_u32 s48, s48, 0x8000
    s_add_u32 m0, s54, 28672
    s_and_b32 s48, s48, 0x1fffff
    buffer_load_dwordx4 v8, s[36:39], s48 offen lds
    s_cmp_lg_u32 s42, 3
    s_cbranch_scc1 O_ready
    s_mov_b32 exec_hi, 0
    s_mov_b32 exec_lo, s73
    s_waitcnt vmcnt(8)
    s_branch O_chk
O_poll:
    s_sleep 1
    buffer_load_dwordx2 v[6:7], v4, s[32:35], s50 offen sc1
    s_waitcnt vmcnt(0)
O_chk:
    v_xor_b32 v6, v30, v6
    v_xor_b32 v7, v31, v7
    v_or_b32 v6, v6, v7
    v_cmp_ne_u32 vcc, 0, v6
    s_add_u32 s49, s49, 1
    s_cbranch_vccz O_ready
    s_cmp_lt_u32 s49, 131072
    s_cbranch_scc1 O_poll
O_ready:
    s_mov_b64 exec, -1
    s_barrier
    s_add_u32 s52, s52, 0x1000
    s_add_u32 m0, s54, 81920
    s_and_b32 s52, s52, 0xffff
    buffer_load_dwordx4 v9, s[32:35], s52 offen sc1 lds
    s_add_u32 m0, s54, 86016
    s_nop 0
    buffer_load_dwordx4 v10, s[32:35], s52 offen sc1 lds
    s_add_u32 s52, s52, 0x1000
    s_add_u32 m0, s54, 90112
    s_and_b32 s52, s52, 0xffff
    buffer_load_dwordx4 v9, s[32:35], s52 offen sc1 lds
    s_add_u32 m0, s54, 94208
    s_nop 0
    buffer_load_dwordx4 v10, s[32:35], s52 offen sc1 lds
    s_add_u32 s52, s52, 0x1000
    s_add_u32 m0, s54, 131072
    s_and_b32 s52, s52, 0xffff
    buffer_load_dwordx4 v9, s[32:35], s52 offen sc1 lds
    s_add_u32 m0, s54, 135168
    s_nop 0
    buffer_load_dwordx4 v10, s[32:35], s52 offen sc1 lds
    s_add_u32 s52, s52, 0x1000
    s_add_u32 m0, s54, 139264
    s_and_b32 s52, s52, 0xffff
    buffer_load_dwordx4 v9, s[32:35], s52 offen sc1 lds
    s_add_u32 m0, s54, 143360
    s_nop 0
    buffer_load_dwordx4 v10, s[32:35], s52 offen sc1 lds
    s_add_u32 s52, s52, 0x1000
    s_add_u32 m0, s54, 65536
    s_and_b32 s52, s52, 0xffff
    buffer_load_dwordx4 v9, s[32:35], s52 offen sc1 lds
    s_add_u32 m0, s54, 69632
    s_nop 0
    buffer_load_dwordx4 v10, s[32:35], s52 offen sc1 lds
    s_add_u32 s52, s52, 0x1000
    s_add_u32 m0, s54, 73728
    s_and_b32 s52, s52, 0xffff
    buffer_load_dwordx4 v9, s[32:35], s52 offen sc1 lds
    s_add_u32 m0, s54, 77824
    s_nop 0
    buffer_load_dwordx4 v10, s[32:35], s52 offen sc1 lds
    s_waitcnt vmcnt(10)
    s_barrier
    s_waitcnt vmcnt(8)
    s_barrier
    s_waitcnt vmcnt(6)
    s_barrier
O_steps:
    s_add_u32 s48, s48, 0x8000
    s_add_u32 m0, s54, 32768
    s_and_b32 s48, s48, 0x1fffff
    buffer_load_dwordx4 v8, s[36:39], s48 offen lds
    s_add_u32 s48, s48, 0x8000
    s_add_u32 m0, s54, 36864
    s_and_b32 s48, s48, 0x1fffff
    buffer_load_dwordx4 v8, s[36:39], s48 offen lds
    s_add_u32 s48, s48, 0x8000
    s_add_u32 m0, s54, 40960
    s_and_b32 s48, s48, 0x1fffff
    buffer_load_dwordx4 v8, s[36:39], s48 offen lds
    s_add_u32 s52, s52, 0x1000
    s_add_u32 m0, s54, 81920
    s_and_b32 s52, s52, 0xffff
    buffer_load_dwordx4 v9, s[32:35], s52 offen sc1 lds
    s_add_u32 m0, s54, 86016
    s_nop 0
    buffer_load_dwordx4 v10, s[32:35], s52 offen sc1 lds
    s_waitcnt vmcnt(9)
    s_barrier
    s_add_u32 s48, s48, 0x8000
    s_add_u32 m0, s54, 45056
    s_and_b32 s48, s48, 0x1fffff
    buffer_load_dwordx4 v8, s[36:39], s48 offen lds
    s_add_u32 s48, s48, 0x8000
    s_add_u32 m0, s54, 49152
    s_and_b32 s48, s48, 0x1fffff
    buffer_load_dwordx4 v8, s[36:39], s48 offen lds
    s_add_u32 s48, s48, 0x8000
    s_add_u32 m0, s54, 53248
    s_and_b32 s48, s48, 0x1fffff
    buffer_load_dwordx4 v8, s[36:39], s48 offen lds
    s_add_u32 s52, s52, 0x1000
    s_add_u32 m0, s54, 90112
    s_and_b32 s52, s52, 0xffff
    buffer_load_dwordx4 v9, s[32:35], s52 offen sc1 lds
    s_add_u32 m0, s54, 94208
    s_nop 0
    buffer_load_dwordx4 v10, s[32:35], s52 offen sc1 lds
    s_waitcnt vmcnt(12)
    s_barrier
    s_add_u32 s48, s48, 0x8000
    s_add_u32 m0, s54, 57344
    s_and_b32 s48, s48, 0x1fffff
    buffer_load_dwordx4 v8, s[36:39], s48 offen lds
    s_add_u32 s48, s48, 0x8000
    s_add_u32 m0, s54, 61440
    s_and_b32 s48, s48, 0x1fffff
    buffer_load_dwordx4 v8, s[36:39], s48 offen lds
    s_add_u32 s48, s48, 0x8000
    s_add_u32 m0, s54, 98304
    s_and_b32 s48, s48, 0x1fffff
    buffer_load_dwordx4 v8, s[36:39], s48 offen lds
    s_add_u32 s52, s52, 0x1000
    s_add_u32 m0, s54, 131072
    s_and_b32 s52, s52, 0xffff
    buffer_load_dwordx4 v9, s[32:35], s52 offen sc1 lds
    s_add_u32 m0, s54, 135168
    s_nop 0
    buffer_load_dwordx4 v10, s[32:35], s52 offen sc1 lds
    s_waitcnt vmcnt(15)
    s_barrier
    s_add_u32 s48, s48, 0x8000
    s_add_u32 m0, s54, 102400
    s_and_b32 s48, s48, 0x1fffff
    buffer_load_dwordx4 v8, s[36:39], s48 offen lds
    s_add_u32 s48, s48, 0x8000
    s_add_u32 m0, s54, 106496
    s_and_b32 s48, s48, 0x1fffff
    buffer_load_dwordx4 v8, s[36:39], s48 offen lds
    s_add_u32 s48, s48, 0x8000
    s_add_u32 m0, s54, 110592
    s_and_b32 s48, s48, 0x1fffff
    buffer_load_dwordx4 v8, s[36:39], s48 offen lds
    s_add_u32 s52, s52, 0x1000
    s_add_u32 m0, s54, 139264
    s_and_b32 s52, s52, 0xffff
    buffer_load_dwordx4 v9, s[32:35], s52 offen sc1 lds
    s_add_u32 m0, s54, 143360
    s_nop 0
    buffer_load_dwordx4 v10, s[32:35], s52 offen sc1 lds
    s_waitcnt vmcnt(12)
    s_barrier
    s_add_u32 s48, s48, 0x8000
    s_add_u32 m0, s54, 114688
    s_and_b32 s48, s48, 0x1fffff
    buffer_load_dwordx4 v8, s[36:39], s48 offen lds
    s_add_u32 s48, s48, 0x8000
    s_add_u32 m0, s54, 118784
    s_and_b32 s48, s48, 0x1fffff
    buffer_load_dwordx4 v8, s[36:39], s48 offen lds
    s_add_u32 s48, s48, 0x8000
    s_add_u32 m0, s54, 122880
    s_and_b32 s48, s48, 0x1fffff
    buffer_load_dwordx4 v8, s[36:39], s48 offen lds
    s_add_u32 s52, s52, 0x1000
    s_add_u32 m0, s54, 65536
    s_and_b32 s52, s52, 0xffff
    buffer_load_dwordx4 v9, s[32:35], s52 offen sc1 lds
    s_add_u32 m0, s54, 69632
    s_nop 0
    buffer_load_dwordx4 v10, s[32:35], s52 offen sc1 lds
    s_waitcnt vmcnt(12)
    s_barrier
    s_add_u32 s48, s48, 0x8000
    s_add_u32 m0, s54, 126976
    s_and_b32 s48, s48, 0x1fffff
    buffer_load_dwordx4 v8, s[36:39], s48 offen lds
    s_add_u32 s48, s48, 0x8000
    s_add_u32 m0, s54, 0
    s_and_b32 s48, s48, 0x1fffff
    buffer_load_dwordx4 v8, s[36:39], s48 offen lds
    s_add_u32 s48, s48, 0x8000
    s_add_u32 m0, s54, 4096
    s_and_b32 s48, s48, 0x1fffff
    buffer_load_dwordx4 v8, s[36:39], s48 offen lds
    s_add_u32 s52, s52, 0x1000
    s_add_u32 m0, s54, 73728
    s_and_b32 s52, s52, 0xffff
    buffer_load_dwordx4 v9, s[32:35], s52 offen sc1 lds
    s_add_u32 m0, s54, 77824
    s_nop 0
    buffer_load_dwordx4 v10, s[32:35], s52 offen sc1 lds
    s_waitcnt vmcnt(12)
    s_barrier
    s_add_u32 s48, s48, 0x8000
    s_add_u32 m0, s54, 8192
    s_and_b32 s48, s48, 0x1fffff
    buffer_load_dwordx4 v8, s[36:39], s48 offen lds
    s_add_u32 s48, s48, 0x8000
    s_add_u32 m0, s54, 12288
    s_and_b32 s48, s48, 0x1fffff
    buffer_load_dwordx4 v8, s[36:39], s48 offen lds
    s_add_u32 s48, s48, 0x8000
    s_add_u32 m0, s54, 16384
    s_and_b32 s48, s48, 0x1fffff
    buffer_load_dwordx4 v8, s[36:39], s48 offen lds
    s_add_u32 s52, s52, 0x1000
    s_add_u32 m0, s54, 81920
    s_and_b32 s52, s52, 0xffff
    buffer_load_dwordx4 v9, s[32:35], s52 offen sc1 lds
    s_add_u32 m0, s54, 86016
    s_nop 0
    buffer_load_dwordx4 v10, s[32:35], s52 offen sc1 lds
    s_waitcnt vmcnt(7)
    s_barrier
    s_add_u32 s48, s48, 0x8000
    s_add_u32 m0, s54, 20480
    s_and_b32 s48, s48, 0x1fffff
    buffer_load_dwordx4 v8, s[36:39], s48 offen lds
    s_add_u32 s48, s48, 0x8000
    s_add_u32 m0, s54, 24576
    s_and_b32 s48, s48, 0x1fffff
    buffer_load_dwordx4 v8, s[36:39], s48 offen lds
    s_add_u32 s48, s48, 0x8000
    s_add_u32 m0, s54, 28672
    s_and_b32 s48, s48, 0x1fffff
    buffer_load_dwordx4 v8, s[36:39], s48 offen lds
    s_add_u32 s52, s52, 0x1000
    s_add_u32 m0, s54, 90112
    s_and_b32 s52, s52, 0xffff
    buffer_load_dwordx4 v9, s[32:35], s52 offen sc1 lds
    s_add_u32 m0, s54, 94208
    s_nop 0
    buffer_load_dwordx4 v10, s[32:35], s52 offen sc1 lds
    s_waitcnt vmcnt(7)
    s_barrier
    s_add_u32 s48, s48, 0x8000
    s_add_u32 m0, s54, 32768
    s_and_b32 s48, s48, 0x1fffff
    buffer_load_dwordx4 v8, s[36:39], s48 offen lds
    s_add_u32 s48, s48, 0x8000
    s_add_u32 m0, s54, 36864
    s_and_b32 s48, s48, 0x1fffff
    buffer_load_dwordx4 v8, s[36:39], s48 offen lds
    s_add_u32 s48, s48, 0x8000
    s_add_u32 m0, s54, 40960
    s_and_b32 s48, s48, 0x1fffff
    buffer_load_dwordx4 v8, s[36:39], s48 offen lds
    s_add_u32 s48, s48, 0x8000
    s_add_u32 m0, s54, 45056
    s_and_b32 s48, s48, 0x1fffff
    buffer_load_dwordx4 v8, s[36:39], s48 offen lds
    s_waitcnt vmcnt(6)
    s_barrier
    s_add_u32 s48, s48, 0x8000
    s_add_u32 m0, s54, 49152
    s_and_b32 s48, s48, 0x1fffff
    buffer_load_dwordx4 v8, s[36:39], s48 offen lds
    s_add_u32 s48, s48, 0x8000
    s_add_u32 m0, s54, 53248
    s_and_b32 s48, s48, 0x1fffff
    buffer_load_dwordx4 v8, s[36:39], s48 offen lds
    s_add_u32 s48, s48, 0x8000
    s_add_u32 m0, s54, 57344
    s_and_b32 s48, s48, 0x1fffff
    buffer_load_dwordx4 v8, s[36:39], s48 offen lds
    s_add_u32 s48, s48, 0x8000
    s_add_u32 m0, s54, 61440
    s_and_b32 s48, s48, 0x1fffff
    buffer_load_dwordx4 v8, s[36:39], s48 offen lds
    s_waitcnt vmcnt(4)
    s_barrier
    s_waitcnt vmcnt(0)
    s_barrier
    s_branch K_fin
K_fallback:
    v_mov_b32 v72, 0
    v_mov_b32 v73, 0
    v_mov_b32 v74, 0
    v_mov_b32 v75, 0
    v_mov_b32 v76, 0
    v_mov_b32 v77, 0
    v_mov_b32 v78, 0
    v_mov_b32 v79, 0
    v_mov_b32 v80, 0
    v_mov_b32 v81, 0
    v_mov_b32 v82, 0
    v_mov_b32 v83, 0
    v_mov_b32 v84, 0
    v_mov_b32 v85, 0
    v_mov_b32 v86, 0
    v_mov_b32 v87, 0
    v_mov_b32 v88, 0
    v_mov_b32 v89, 0
    v_mov_b32 v90, 0
    v_mov_b32 v91, 0
    v_mov_b32 v92, 0
    v_mov_b32 v93, 0
    v_mov_b32 v94, 0
    v_mov_b32 v95, 0
    v_mov_b32 v96, 0
    v_mov_b32 v97, 0
    v_mov_b32 v98, 0
    v_mov_b32 v99, 0
    v_mov_b32 v100, 0
    v_mov_b32 v101, 0
    v_mov_b32 v102, 0
    v_mov_b32 v103, 0
    v_mov_b32 v104, 0
    v_mov_b32 v105, 0
    v_mov_b32 v106, 0
    v_mov_b32 v107, 0
    v_mov_b32 v108, 0
    v_mov_b32 v109, 0
    v_mov_b32 v110, 0
    v_mov_b32 v111, 0
    v_mov_b32 v153, 0xff800000
    v_mov_b32 v154, 0xff800000
    s_mov_b32 s49, 0
    s_mov_b32 s48, 10485760
K_fb_loop:
    buffer_load_dwordx4 v[112:115], v3, s[32:35], s48 offen sc1
    buffer_load_dwordx4 v[116:119], v3, s[32:35], s48 offen offset:1024 sc1
    buffer_load_dwordx4 v[128:131], v3, s[32:35], s48 offen offset:2048 sc1
    buffer_load_dwordx4 v[132:135], v3, s[32:35], s48 offen offset:3072 sc1
    s_add_u32 s48, s48, 0x1000
    s_waitcnt vmcnt(0)
    v_mfma_f32_32x32x16_bf16 v[24:39], v[112:115], v[8:11], 0
    v_mfma_f32_32x32x16_bf16 v[24:39], v[116:119], v[12:15], v[24:39]
    s_nop 15
    v_max3_f32 v4, v24, v25, v153
    v_max3_f32 v4, v26, v27, v4
    v_max3_f32 v4, v28, v29, v4
    v_max3_f32 v4, v30, v31, v4
    v_max3_f32 v4, v32, v33, v4
    v_max3_f32 v4, v34, v35, v4
    v_max3_f32 v4, v36, v37, v4
    v_max3_f32 v4, v38, v39, v4
    v_mov_b32 v5, v4
    s_nop 1
    v_permlane32_swap_b32 v4, v5
    s_nop 1
    v_max_f32 v4, v4, v5
    v_sub_f32 v5, v153, v4
    v_exp_f32 v5, v5
    v_mov_b32 v153, v4
    v_sub_f32 v24, v24, v4
    v_sub_f32 v25, v25, v4
    v_sub_f32 v26, v26, v4
    v_sub_f32 v27, v27, v4
    v_sub_f32 v28, v28, v4
    v_sub_f32 v29, v29, v4
    v_sub_f32 v30, v30, v4
    v_sub_f32 v31, v31, v4
    v_sub_f32 v32, v32, v4
    v_sub_f32 v33, v33, v4
    v_sub_f32 v34, v34, v4
    v_sub_f32 v35, v35, v4
    v_sub_f32 v36, v36, v4
    v_sub_f32 v37, v37, v4
    v_sub_f32 v38, v38, v4
    v_sub_f32 v39, v39, v4
    v_exp_f32 v24, v24
    v_exp_f32 v25, v25
    v_exp_f32 v26, v26
    v_exp_f32 v27, v27
    v_exp_f32 v28, v28
    v_exp_f32 v29, v29
    v_exp_f32 v30, v30
    v_exp_f32 v31, v31
    v_exp_f32 v32, v32
    v_exp_f32 v33, v33
    v_exp_f32 v34, v34
    v_exp_f32 v35, v35
    v_exp_f32 v36, v36
    v_exp_f32 v37, v37
    v_exp_f32 v38, v38
    v_exp_f32 v39, v39
    v_mul_f32 v72, v72, v5
    v_mul_f32 v73, v73, v5
    v_mul_f32 v74, v74, v5
    v_mul_f32 v75, v75, v5
    v_mul_f32 v76, v76, v5
    v_mul_f32 v77, v77, v5
    v_mul_f32 v78, v78, v5
    v_mul_f32 v79, v79, v5
    v_mul_f32 v80, v80, v5
    v_mul_f32 v81, v81, v5
    v_mul_f32 v82, v82, v5
    v_mul_f32 v83, v83, v5
    v_mul_f32 v84, v84, v5
    v_mul_f32 v85, v85, v5
    v_mul_f32 v86, v86, v5
    v_mul_f32 v87, v87, v5
    v_mul_f32 v104, v104, v5
    v_mul_f32 v105, v105, v5
    v_mul_f32 v106, v106, v5
    v_mul_f32 v107, v107, v5
    v_cvt_pk_bf16_f32 v56, v24, v25
    v_cvt_pk_bf16_f32 v57, v26, v27
    v_cvt_pk_bf16_f32 v58, v28, v29
    v_cvt_pk_bf16_f32 v59, v30, v31
    v_cvt_pk_bf16_f32 v60, v32, v33
    v_cvt_pk_bf16_f32 v61, v34, v35
    v_cvt_pk_bf16_f32 v62, v36, v37
    v_cvt_pk_bf16_f32 v63, v38, v39
    s_nop 1
    v_mfma_f32_32x32x16_bf16 v[72:87], v[128:131], v[56:59], v[72:87]
    v_mfma_f32_32x32x16_bf16 v[72:87], v[132:135], v[60:63], v[72:87]
    v_smfmac_f32_16x16x64_bf16 v[104:107], v[144:147], v[56:63], v148
    s_nop 15
    v_mfma_f32_32x32x16_bf16 v[24:39], v[112:115], v[16:19], 0
    v_mfma_f32_32x32x16_bf16 v[24:39], v[116:119], v[20:23], v[24:39]
    s_nop 15
    v_max3_f32 v4, v24, v25, v154
    v_max3_f32 v4, v26, v27, v4
    v_max3_f32 v4, v28, v29, v4
    v_max3_f32 v4, v30, v31, v4
    v_max3_f32 v4, v32, v33, v4
    v_max3_f32 v4, v34, v35, v4
    v_max3_f32 v4, v36, v37, v4
    v_max3_f32 v4, v38, v39, v4
    v_mov_b32 v5, v4
    s_nop 1
    v_permlane32_swap_b32 v4, v5
    s_nop 1
    v_max_f32 v4, v4, v5
    v_sub_f32 v5, v154, v4
    v_exp_f32 v5, v5
    v_mov_b32 v154, v4
    v_sub_f32 v24, v24, v4
    v_sub_f32 v25, v25, v4
    v_sub_f32 v26, v26, v4
    v_sub_f32 v27, v27, v4
    v_sub_f32 v28, v28, v4
    v_sub_f32 v29, v29, v4
    v_sub_f32 v30, v30, v4
    v_sub_f32 v31, v31, v4
    v_sub_f32 v32, v32, v4
    v_sub_f32 v33, v33, v4
    v_sub_f32 v34, v34, v4
    v_sub_f32 v35, v35, v4
    v_sub_f32 v36, v36, v4
    v_sub_f32 v37, v37, v4
    v_sub_f32 v38, v38, v4
    v_sub_f32 v39, v39, v4
    v_exp_f32 v24, v24
    v_exp_f32 v25, v25
    v_exp_f32 v26, v26
    v_exp_f32 v27, v27
    v_exp_f32 v28, v28
    v_exp_f32 v29, v29
    v_exp_f32 v30, v30
    v_exp_f32 v31, v31
    v_exp_f32 v32, v32
    v_exp_f32 v33, v33
    v_exp_f32 v34, v34
    v_exp_f32 v35, v35
    v_exp_f32 v36, v36
    v_exp_f32 v37, v37
    v_exp_f32 v38, v38
    v_exp_f32 v39, v39
    v_mul_f32 v88, v88, v5
    v_mul_f32 v89, v89, v5
    v_mul_f32 v90, v90, v5
    v_mul_f32 v91, v91, v5
    v_mul_f32 v92, v92, v5
    v_mul_f32 v93, v93, v5
    v_mul_f32 v94, v94, v5
    v_mul_f32 v95, v95, v5
    v_mul_f32 v96, v96, v5
    v_mul_f32 v97, v97, v5
    v_mul_f32 v98, v98, v5
    v_mul_f32 v99, v99, v5
    v_mul_f32 v100, v100, v5
    v_mul_f32 v101, v101, v5
    v_mul_f32 v102, v102, v5
    v_mul_f32 v103, v103, v5
    v_mul_f32 v108, v108, v5
    v_mul_f32 v109, v109, v5
    v_mul_f32 v110, v110, v5
    v_mul_f32 v111, v111, v5
    v_cvt_pk_bf16_f32 v56, v24, v25
    v_cvt_pk_bf16_f32 v57, v26, v27
    v_cvt_pk_bf16_f32 v58, v28, v29
    v_cvt_pk_bf16_f32 v59, v30, v31
    v_cvt_pk_bf16_f32 v60, v32, v33
    v_cvt_pk_bf16_f32 v61, v34, v35
    v_cvt_pk_bf16_f32 v62, v36, v37
    v_cvt_pk_bf16_f32 v63, v38, v39
    s_nop 1
    v_mfma_f32_32x32x16_bf16 v[88:103], v[128:131], v[56:59], v[88:103]
    v_mfma_f32_32x32x16_bf16 v[88:103], v[132:135], v[60:63], v[88:103]
    v_smfmac_f32_16x16x64_bf16 v[108:111], v[144:147], v[56:63], v148
    s_nop 15
    s_add_u32 s49, s49, 1
    s_cmp_lt_u32 s49, 64
    s_cbranch_scc1 K_fb_loop
    v_add_f32 v104, v104, v105
    v_add_f32 v108, v108, v109
    v_rcp_f32 v6, v104
    s_nop 0
    v_pk_mul_f32 v[72:73], v[72:73], v[6:7] op_sel_hi:[1,0]
    v_pk_mul_f32 v[74:75], v[74:75], v[6:7] op_sel_hi:[1,0]
    v_pk_mul_f32 v[76:77], v[76:77], v[6:7] op_sel_hi:[1,0]
    v_pk_mul_f32 v[78:79], v[78:79], v[6:7] op_sel_hi:[1,0]
    v_pk_mul_f32 v[80:81], v[80:81], v[6:7] op_sel_hi:[1,0]
    v_pk_mul_f32 v[82:83], v[82:83], v[6:7] op_sel_hi:[1,0]
    v_pk_mul_f32 v[84:85], v[84:85], v[6:7] op_sel_hi:[1,0]
    v_pk_mul_f32 v[86:87], v[86:87], v[6:7] op_sel_hi:[1,0]
    v_cvt_pk_bf16_f32 v56, v72, v73
    v_cvt_pk_bf16_f32 v57, v74, v75
    v_cvt_pk_bf16_f32 v58, v76, v77
    v_cvt_pk_bf16_f32 v59, v78, v79
    v_cvt_pk_bf16_f32 v60, v80, v81
    v_cvt_pk_bf16_f32 v61, v82, v83
    v_cvt_pk_bf16_f32 v62, v84, v85
    v_cvt_pk_bf16_f32 v63, v86, v87
    buffer_store_dwordx4 v[56:59], v3, s[32:35], s45 offen sc1
    buffer_store_dwordx4 v[60:63], v3, s[32:35], s45 offen offset:1024 sc1
    s_branch K_normB
K_codeend:
.section .rodata,"a"
.p2align 6
.amdhsa_kernel gated_mix__grouped_kv_mqa__moe_arch_mod__prompt_kernel
  .amdhsa_next_free_vgpr 256
  .amdhsa_next_free_sgpr 80
  .amdhsa_accum_offset 256
  .amdhsa_group_segment_fixed_size 0
  .amdhsa_kernarg_size 112
  .amdhsa_user_sgpr_count 2
  .amdhsa_user_sgpr_kernarg_segment_ptr 1
  .amdhsa_system_sgpr_workgroup_id_x 1
  .amdhsa_float_denorm_mode_32 3
.end_amdhsa_kernel
```
